```python
import torch

def _softmax(x, axis=-1):
    return torch.softmax(x, dim=axis)
def _gelu(x):
    return torch.nn.functional.gelu(x, approximate="tanh")
def _silu(x):
    return torch.nn.functional.silu(x)
def _sigmoid(x):
    return torch.sigmoid(x)
def _layernorm(x, axis=-1, eps=1e-5):
    m = x.mean(dim=axis, keepdim=True)
    v = x.var(dim=axis, keepdim=True, unbiased=False)
    return (x - m) / torch.sqrt(v + eps)
def _scatter_add(tgt, idx, src, axis=0):
    return tgt.clone().index_add_(axis, idx, src)
def _segment_sum(src, seg, n):
    out = torch.zeros((n,) + src.shape[1:], dtype=src.dtype)
    return out.index_add_(0, seg, src)
def _pad(x, pw):
    flat = tuple(v for pair in reversed(pw) for v in pair)
    return torch.nn.functional.pad(x, flat)

kernel_name = 'recurrent_scan__gqa_block_cached__mixer_channel_mlp__decode'

def setup_inputs():

    _w = (lambda a: (lambda t: t.to(torch.bfloat16) if t.is_floating_point() else t)(torch.as_tensor(a)))
    def _A_setup():
        B, Sq, D = 2, 1, 512
        Hq, Hkv, Sk, Dh = 32, 8, 8192, 128
        assert Hq % Hkv == 0, (Hq, Hkv)
        return {
            "x": _w((lambda *s: torch.randn(*s, dtype=torch.bfloat16) * 0.1)(B, Sq, D)),
            "k_cache": _w((lambda *s: torch.randn(*s, dtype=torch.bfloat16) * 0.8)(B, Hkv, Sk, Dh)),
            "v_cache": _w((lambda *s: torch.randn(*s, dtype=torch.bfloat16) * 3.2)(B, Hkv, Sk, Dh)),
            "wq": _w((lambda *s: torch.randn(*s, dtype=torch.bfloat16) * 0.8)(D, Hq * Dh) * (D ** -0.5)),
            "wo": _w((lambda *s: torch.randn(*s, dtype=torch.bfloat16) * 3.2)(Hq * Dh, D) * ((Hq * Dh) ** -0.5)),
        }
    _A_in = _A_setup()

    def _B_setup():
        B, S, D, F = 2, 1, 512, 1792
        return {
            "x": _w((lambda *s: torch.randn(*s, dtype=torch.bfloat16) * 0.1)(B, S, D)),
            "w1": _w((lambda *s: torch.randn(*s, dtype=torch.bfloat16) * 3.2)(D, F) * (D ** -0.5)),
            "b1": _w((lambda *s: torch.randn(*s, dtype=torch.bfloat16) * 3.2)(F)),
            "w2": _w((lambda *s: torch.randn(*s, dtype=torch.bfloat16) * 3.2)(F, D) * (F ** -0.5)),
            "b2": _w((lambda *s: torch.randn(*s, dtype=torch.bfloat16) * 3.2)(D)),
        }
    _B_in = _B_setup()

    return {
        "A_x": _A_in["x"],
        "A_k_cache": _A_in["k_cache"],
        "A_v_cache": _A_in["v_cache"],
        "A_wq": _A_in["wq"],
        "A_wo": _A_in["wo"],
        "B_x": _B_in["x"],
        "B_w1": _B_in["w1"],
        "B_b1": _B_in["b1"],
        "B_w2": _B_in["w2"],
        "B_b2": _B_in["b2"],
    }

def reference(A_x, A_k_cache, A_v_cache, A_wq, A_wo, B_x, B_w1, B_b1, B_w2, B_b2):
    def _A_ref(x, k_cache, v_cache, wq, wo):
        B, Sq, D = x.shape
        Hq, Dh = 32, 128
        Hkv = k_cache.shape[1]
        rep = Hq // Hkv
        q = (lambda x, *d: x.permute(*d))((x @ wq).reshape(B, Sq, Hq, Dh), 0, 2, 1, 3)
        k = (lambda x, n, axis: torch.repeat_interleave(x, n, dim=axis))(k_cache, rep, axis=1)
        v = (lambda x, n, axis: torch.repeat_interleave(x, n, dim=axis))(v_cache, rep, axis=1)
        scores = torch.einsum("bhqd,bhkd->bhqk", q, k) * (Dh ** -0.5)
        p = _softmax(scores, axis=-1)
        o = torch.einsum("bhqk,bhkd->bhqd", p, v)
        return (lambda x, *d: x.permute(*d))(o, 0, 2, 1, 3).reshape(B, Sq, Hq * Dh) @ wo

    def _B_ref(x, w1, b1, w2, b2):
        y = _layernorm(x, axis=-1)
        h = _gelu(torch.einsum("bsd,df->bsf", y, w1) + b1)
        return torch.einsum("bsf,fd->bsd", h, w2) + b2

    x = A_x
    xn = _layernorm(x, axis=-1)
    s = _A_ref(xn, A_k_cache, A_v_cache, A_wq, A_wo)
    g = _silu(_B_ref(xn, B_w1, B_b1, B_w2, B_b2))
    return x + s * g
```

```asm
; @launch grid=(256,1,1) block=(704,1,1) lds=158464
.amdgcn_target "amdgcn-amd-amdhsa--gfx950"
.text
.globl recurrent_scan__gqa_block_cached__mixer_channel_mlp__decode_kernel
.p2align 8
.type recurrent_scan__gqa_block_cached__mixer_channel_mlp__decode_kernel,@function
recurrent_scan__gqa_block_cached__mixer_channel_mlp__decode_kernel:
  s_load_dwordx16 s[4:19], s[0:1], 0
  s_load_dwordx8 s[20:27], s[0:1], 64
  s_load_dwordx2 s[28:29], s[0:1], 96
  v_lshrrev_b32 v1, 6, v0
  s_lshr_b32 s31, s2, 3
  v_and_b32 v0, 63, v0
  v_readfirstlane_b32 s3, v1
  s_cmp_ge_u32 s31, 32
  s_cbranch_scc1 L_end
  s_and_b32 s30, s2, 7
  v_lshrrev_b32 v6, 4, v0
  v_and_b32 v7, 15, v0
  s_mov_b32 s35, 0x20000
  s_sub_u32 s57, s3, 3
  s_cbranch_scc1 L_svc
  s_lshr_b32 s44, s31, 4
  s_lshl_b32 s44, s44, 3
  s_add_u32 s44, s44, s30
  s_lshl_b32 s44, s44, 4
  s_and_b32 s45, s31, 15
  s_add_u32 s44, s44, s45
  s_lshl_b32 s44, s44, 7
  s_add_u32 s44, s44, s57
  s_lshl_b32 s44, s44, 10
  v_lshlrev_b32 v1, 2, v6
  v_xor_b32 v1, v1, v7
  v_lshlrev_b32 v1, 4, v1
  v_lshl_add_u32 v1, v6, 8, v1
  v_xor_b32 v2, 16, v1
  v_xor_b32 v3, 32, v1
  v_xor_b32 v4, 48, v1
  s_lshl_b32 s56, s57, 14
  s_mov_b32 m0, s56
  s_mov_b32 s46, s44
  s_lshl_b32 s34, s35, 8
  s_movk_i32 s45, 0x2000
  s_movk_i32 s47, 0x400
  v_mov_b64 v[16:17], -1
  v_mov_b64 v[18:19], -1
  s_mulk_i32 s57, 704
  v_lshlrev_b32 v31, 4, v0
  s_add_u32 s57, s57, s35
  v_add_u32 v8, s57, v31
  ds_write_b128 v8, v[16:19]
  s_waitcnt lgkmcnt(0)
  s_mov_b64 s[32:33], s[6:7]
  buffer_load_dwordx4 v1, s[32:35], s44 offen nt lds
  s_add_u32 m0, m0, s47
  s_add_u32 s44, s44, s45
  buffer_load_dwordx4 v2, s[32:35], s44 offen nt lds
  s_add_u32 m0, m0, s47
  s_add_u32 s44, s44, s45
  s_branch L_bulk
L_svc:
  s_setprio 3
  v_and_b32 v2, 7, v0
  s_mov_b32 s39, s35
  s_cmp_eq_u32 s3, 1
  s_cbranch_scc1 L_pq
  s_cmp_eq_u32 s3, 2
  s_cbranch_scc1 L_pm
  v_lshrrev_b32 v1, 3, v7
  v_lshlrev_b32 v1, 10, v1
  v_lshl_add_u32 v1, v6, 7, v1
  v_lshl_add_u32 v1, v2, 4, v1
  s_movk_i32 s34, 2048
  s_waitcnt lgkmcnt(0)
  s_mov_b64 s[32:33], s[4:5]
  buffer_load_dwordx4 v[8:11], v1, s[32:35], 0 offen
  buffer_load_dwordx4 v[12:15], v1, s[32:35], 0 offen offset:512
  s_getpc_b64 s[44:45]
L_pc:
  s_lshl_b32 s46, s31, 9
  v_lshl_add_u32 v3, v6, 7, s46
  v_min_u32 v3, L_end-L_pc, v3
  global_load_dword v55, v3, s[44:45]
  v_mov_b32 v3, 0
  global_load_dword v59, v3, s[28:29] offset:0 sc1
  s_barrier
  s_branch L_ctl
L_pq:
  s_lshr_b32 s51, s31, 3
  s_and_b32 s47, s31, 7
  s_add_u32 s50, s51, 4
  s_cmp_eq_u32 s47, 3
  s_cselect_b32 s47, s50, s47
  s_cselect_b32 s51, 3, s51
  s_sub_u32 s50, s31, 28
  s_cselect_b32 s47, s47, 3
  s_cselect_b32 s51, s51, s50
  s_movk_i32 s45, 0x2000
  s_lshl_b32 s46, s30, 10
  s_lshl_b32 s50, s47, 7
  s_add_u32 s46, s46, s50
  s_lshl_b32 s50, s51, 20
  s_add_u32 s46, s46, s50
  v_lshrrev_b32 v31, 3, v0
  v_lshlrev_b32 v31, 17, v31
  v_lshl_add_u32 v31, v2, 4, v31
  s_mov_b32 s38, 0x400000
  s_waitcnt lgkmcnt(0)
  s_mov_b64 s[36:37], s[10:11]
  s_branch L_load16
L_pm:
  s_lshr_b32 s48, s30, 1
  s_mul_i32 s48, s48, 28
  s_add_u32 s48, s48, s31
  s_lshr_b32 s49, s48, 2
  s_and_b32 s48, s48, 3
  s_mov_b32 s38, 1835008
  s_cmp_ge_u32 s31, 28
  s_cbranch_scc1 L_nojob
  s_bitcmp1_b32 s30, 0
  s_cbranch_scc1 L_nojob
  s_movk_i32 s45, 3584
  s_lshl_b32 s46, s49, 7
  s_mul_i32 s50, s48, 458752
  s_add_u32 s46, s46, s50
  v_lshrrev_b32 v31, 3, v0
  v_mul_u32_u24 v31, 57344, v31
  v_lshl_add_u32 v31, v2, 4, v31
  s_waitcnt lgkmcnt(0)
  s_mov_b64 s[36:37], s[16:17]
L_load16:
  buffer_load_dwordx4 v[64:67], v31, s[36:39], s46 offen nt
  s_add_u32 s46, s46, s45
  buffer_load_dwordx4 v[68:71], v31, s[36:39], s46 offen nt
  s_add_u32 s46, s46, s45
  buffer_load_dwordx4 v[72:75], v31, s[36:39], s46 offen nt
  s_add_u32 s46, s46, s45
  buffer_load_dwordx4 v[76:79], v31, s[36:39], s46 offen nt
  s_add_u32 s46, s46, s45
  buffer_load_dwordx4 v[80:83], v31, s[36:39], s46 offen nt
  s_add_u32 s46, s46, s45
  buffer_load_dwordx4 v[84:87], v31, s[36:39], s46 offen nt
  s_add_u32 s46, s46, s45
  buffer_load_dwordx4 v[88:91], v31, s[36:39], s46 offen nt
  s_add_u32 s46, s46, s45
  buffer_load_dwordx4 v[92:95], v31, s[36:39], s46 offen nt
  s_add_u32 s46, s46, s45
  buffer_load_dwordx4 v[96:99], v31, s[36:39], s46 offen nt
  s_add_u32 s46, s46, s45
  buffer_load_dwordx4 v[100:103], v31, s[36:39], s46 offen nt
  s_add_u32 s46, s46, s45
  buffer_load_dwordx4 v[104:107], v31, s[36:39], s46 offen nt
  s_add_u32 s46, s46, s45
  buffer_load_dwordx4 v[108:111], v31, s[36:39], s46 offen nt
  s_add_u32 s46, s46, s45
  buffer_load_dwordx4 v[112:115], v31, s[36:39], s46 offen nt
  s_add_u32 s46, s46, s45
  buffer_load_dwordx4 v[116:119], v31, s[36:39], s46 offen nt
  s_add_u32 s46, s46, s45
  buffer_load_dwordx4 v[120:123], v31, s[36:39], s46 offen nt
  s_add_u32 s46, s46, s45
  buffer_load_dwordx4 v[124:127], v31, s[36:39], s46 offen nt
L_nojob:
  s_barrier
  s_branch L_svc2
L_bulk:
  s_setprio 2
  s_barrier
  s_sub_u32 s57, s3, 3
  s_mul_i32 s51, s57, 2560
  s_add_u32 s51, s51, 137984
  v_add_u32 v8, s51, v31
  ds_write_b128 v8, v[16:19]
  ds_write_b128 v8, v[16:19] offset:1024
  ds_write_b128 v8, v[16:19] offset:1536
  s_mov_b64 s[36:37], s[8:9]
  s_mov_b32 s38, s34
  s_mov_b32 s39, s35
  s_lshl_b32 s48, s57, 2
  s_add_u32 s48, s48, 132480
  v_mov_b32 v27, s48
  buffer_load_dwordx4 v3, s[32:35], s44 offen nt lds
  s_add_u32 m0, m0, s47
  s_add_u32 s44, s44, s45
  buffer_load_dwordx4 v4, s[32:35], s44 offen nt lds
  s_add_u32 m0, m0, s47
  s_add_u32 s44, s44, s45
  s_add_u32 s49, s44, 655360
  s_and_b32 s49, s49, 0x1fffff
  s_andn2_b32 s44, s44, 0x1fffff
  s_or_b32 s44, s44, s49
  buffer_load_dwordx4 v1, s[32:35], s44 offen nt lds
  s_add_u32 m0, m0, s47
  s_add_u32 s44, s44, s45
  buffer_load_dwordx4 v2, s[32:35], s44 offen nt lds
  s_add_u32 m0, m0, s47
  s_add_u32 s44, s44, s45
  buffer_load_dwordx4 v3, s[32:35], s44 offen nt lds
  s_add_u32 m0, m0, s47
  s_add_u32 s44, s44, s45
  buffer_load_dwordx4 v4, s[32:35], s44 offen nt lds
  s_add_u32 m0, m0, s47
  s_add_u32 s44, s44, s45
  s_add_u32 s49, s44, 655360
  s_and_b32 s49, s49, 0x1fffff
  s_andn2_b32 s44, s44, 0x1fffff
  s_or_b32 s44, s44, s49
  buffer_load_dwordx4 v1, s[32:35], s44 offen nt lds
  s_add_u32 m0, m0, s47
  s_add_u32 s44, s44, s45
  buffer_load_dwordx4 v2, s[32:35], s44 offen nt lds
  s_add_u32 m0, m0, s47
  s_add_u32 s44, s44, s45
  buffer_load_dwordx4 v3, s[32:35], s44 offen nt lds
  s_add_u32 m0, m0, s47
  s_add_u32 s44, s44, s45
  buffer_load_dwordx4 v4, s[32:35], s44 offen nt lds
  s_add_u32 m0, m0, s47
  s_add_u32 s44, s44, s45
  s_add_u32 s49, s44, 655360
  s_and_b32 s49, s49, 0x1fffff
  s_andn2_b32 s44, s44, 0x1fffff
  s_or_b32 s44, s44, s49
  buffer_load_dwordx4 v1, s[32:35], s44 offen nt lds
  s_add_u32 m0, m0, s47
  s_add_u32 s44, s44, s45
  buffer_load_dwordx4 v2, s[32:35], s44 offen nt lds
  s_add_u32 m0, m0, s47
  s_add_u32 s44, s44, s45
  ds_write_b32 v27, v27 offset:64
  buffer_load_dwordx4 v3, s[32:35], s44 offen nt lds
  s_add_u32 m0, m0, s47
  s_add_u32 s44, s44, s45
  buffer_load_dwordx4 v4, s[32:35], s44 offen nt lds
  s_setprio 1
  s_mov_b32 s60, 0x05040100
  s_mov_b32 s61, 0x07060302
  s_mov_b32 s62, 0x200000
  s_mov_b32 s63, 0xfffff000
  s_mov_b64 s[40:41], s[28:29]
  s_mov_b32 s42, 0x10000000
  s_mov_b32 s43, 0x20000
  v_and_b32 v1, 3, v7
  v_lshlrev_b32 v1, 2, v1
  v_lshrrev_b32 v2, 2, v7
  v_add_u32 v1, v1, v2
  v_lshlrev_b32 v1, 8, v1
  v_xor_b32 v2, v6, v7
  v_lshl_add_u32 v1, v2, 4, v1
  v_add_u32 v1, s56, v1
  v_xor_b32 v2, 64, v1
  v_xor_b32 v3, 0x80, v1
  v_xor_b32 v4, 0xc0, v1
  v_and_b32 v30, 3, v7
  v_lshlrev_b32 v29, 8, v30
  v_lshl_add_u32 v29, v6, 4, v29
  v_add_u32 v29, 131072, v29
  s_mov_b32 s52, 0
  buffer_load_dwordx4 v[64:67], v31, s[36:39], s46 offen nt
  s_add_u32 s46, s46, s45
  buffer_load_dwordx4 v[68:71], v31, s[36:39], s46 offen nt
  s_add_u32 s46, s46, s45
  buffer_load_dwordx4 v[72:75], v31, s[36:39], s46 offen nt
  s_add_u32 s46, s46, s45
  buffer_load_dwordx4 v[76:79], v31, s[36:39], s46 offen nt
  s_add_u32 s46, s46, s45
  s_add_u32 s49, s46, 655360
  s_and_b32 s49, s49, 0x1fffff
  s_andn2_b32 s46, s46, 0x1fffff
  s_or_b32 s46, s46, s49
  s_cmp_lg_u32 s52, 0
  s_cbranch_scc1 L_eq3
  ds_read_b32 v28, v29
  s_waitcnt lgkmcnt(0)
  v_cmp_eq_u32 vcc, -1, v28
  s_cmp_lg_u64 vcc, 0
  s_cbranch_scc1 L_eq3
  s_waitcnt vmcnt(4)
  s_call_b64 s[54:55], L_qk
L_eq3:
  buffer_load_dwordx4 v[80:83], v31, s[36:39], s46 offen nt
  s_add_u32 s46, s46, s45
  buffer_load_dwordx4 v[84:87], v31, s[36:39], s46 offen nt
  s_add_u32 s46, s46, s45
  buffer_load_dwordx4 v[88:91], v31, s[36:39], s46 offen nt
  s_add_u32 s46, s46, s45
  buffer_load_dwordx4 v[92:95], v31, s[36:39], s46 offen nt
  s_add_u32 s46, s46, s45
  s_add_u32 s49, s46, 655360
  s_and_b32 s49, s49, 0x1fffff
  s_andn2_b32 s46, s46, 0x1fffff
  s_or_b32 s46, s46, s49
  s_cmp_lg_u32 s52, 0
  s_cbranch_scc1 L_eq7
  ds_read_b32 v28, v29
  s_waitcnt lgkmcnt(0)
  v_cmp_eq_u32 vcc, -1, v28
  s_cmp_lg_u64 vcc, 0
  s_cbranch_scc1 L_eq7
  s_waitcnt vmcnt(8)
  s_call_b64 s[54:55], L_qk
L_eq7:
  buffer_load_dwordx4 v[96:99], v31, s[36:39], s46 offen nt
  s_add_u32 s46, s46, s45
  buffer_load_dwordx4 v[100:103], v31, s[36:39], s46 offen nt
  s_add_u32 s46, s46, s45
  buffer_load_dwordx4 v[104:107], v31, s[36:39], s46 offen nt
  s_add_u32 s46, s46, s45
  buffer_load_dwordx4 v[108:111], v31, s[36:39], s46 offen nt
  s_add_u32 s46, s46, s45
  s_add_u32 s49, s46, 655360
  s_and_b32 s49, s49, 0x1fffff
  s_andn2_b32 s46, s46, 0x1fffff
  s_or_b32 s46, s46, s49
  s_lshl_b32 s49, s57, 2
  s_add_u32 s49, s49, 132512
  v_mov_b32 v28, s49
  ds_write_b32 v28, v28
  s_cmp_lg_u32 s52, 0
  s_cbranch_scc1 L_eq11
  ds_read_b32 v28, v29
  s_waitcnt lgkmcnt(0)
  v_cmp_eq_u32 vcc, -1, v28
  s_cmp_lg_u64 vcc, 0
  s_cbranch_scc1 L_eq11
  s_waitcnt vmcnt(12)
  s_call_b64 s[54:55], L_qk
L_eq11:
  buffer_load_dwordx4 v[112:115], v31, s[36:39], s46 offen nt
  s_add_u32 s46, s46, s45
  buffer_load_dwordx4 v[116:119], v31, s[36:39], s46 offen nt
  s_add_u32 s46, s46, s45
  buffer_load_dwordx4 v[120:123], v31, s[36:39], s46 offen nt
  s_add_u32 s46, s46, s45
  buffer_load_dwordx4 v[124:127], v31, s[36:39], s46 offen nt
  s_lshl_b32 s49, s57, 2
  s_add_u32 s49, s49, 132480
  v_mov_b32 v28, s49
  ds_write_b32 v28, v28
  s_cmp_lg_u32 s52, 0
  s_cbranch_scc1 L_pv
  s_waitcnt vmcnt(16)
  s_getpc_b64 s[54:55]
L_pc2:
  s_add_u32 s54, s54, L_pv-L_pc2
  s_addc_u32 s55, s55, 0
L_qk:
  ds_read_b128 v[32:35], v1 offset:0
  ds_read_b128 v[36:39], v2 offset:0
  ds_read_b128 v[40:43], v3 offset:0
  ds_read_b128 v[44:47], v4 offset:0
  ds_read_b128 v[48:51], v1 offset:4096
  ds_read_b128 v[52:55], v2 offset:4096
  ds_read_b128 v[56:59], v3 offset:4096
  ds_read_b128 v[60:63], v4 offset:4096
L_bq:
  ds_read_b128 v[16:19], v29 offset:0
  ds_read_b128 v[20:23], v29 offset:64
  ds_read_b128 v[24:27], v29 offset:128
  ds_read_b128 v[164:167], v29 offset:192
  s_waitcnt lgkmcnt(0)
  v_max3_u32 v28, v16, v19, v20
  v_max3_u32 v28, v28, v23, v24
  v_max3_u32 v28, v28, v27, v164
  v_max_u32 v28, v28, v167
  v_cmp_eq_u32 vcc, -1, v28
  s_cmp_eq_u64 vcc, 0
  s_cbranch_scc1 L_bq_ok
  s_sleep 4
  s_sub_u32 s62, s62, 1
  s_cbranch_scc0 L_bq
  s_mov_b32 s62, 0
L_bq_ok:
  ds_read_b128 v[128:131], v1 offset:8192
  ds_read_b128 v[132:135], v2 offset:8192
  ds_read_b128 v[136:139], v3 offset:8192
  ds_read_b128 v[140:143], v4 offset:8192
  ds_read_b128 v[144:147], v1 offset:12288
  ds_read_b128 v[148:151], v2 offset:12288
  ds_read_b128 v[152:155], v3 offset:12288
  ds_read_b128 v[156:159], v4 offset:12288
  v_mov_b32 v28, 137728
  ds_read_b32 v5, v28 offset:4
  ds_read_b32 v28, v28
  v_mfma_f32_16x16x32_bf16 v[8:11], v[32:35], v[16:19], 0
  v_mfma_f32_16x16x32_bf16 v[8:11], v[36:39], v[20:23], v[8:11]
  v_mfma_f32_16x16x32_bf16 v[8:11], v[40:43], v[24:27], v[8:11]
  v_mfma_f32_16x16x32_bf16 v[8:11], v[44:47], v[164:167], v[8:11]
  v_mfma_f32_16x16x32_bf16 v[12:15], v[48:51], v[16:19], 0
  v_mfma_f32_16x16x32_bf16 v[12:15], v[52:55], v[20:23], v[12:15]
  v_mfma_f32_16x16x32_bf16 v[12:15], v[56:59], v[24:27], v[12:15]
  v_mfma_f32_16x16x32_bf16 v[12:15], v[60:63], v[164:167], v[12:15]
  s_waitcnt lgkmcnt(6)
  v_mfma_f32_16x16x32_bf16 v[160:163], v[128:131], v[16:19], 0
  v_mfma_f32_16x16x32_bf16 v[160:163], v[132:135], v[20:23], v[160:163]
  v_mfma_f32_16x16x32_bf16 v[160:163], v[136:139], v[24:27], v[160:163]
  v_mfma_f32_16x16x32_bf16 v[160:163], v[140:143], v[164:167], v[160:163]
  s_waitcnt lgkmcnt(0)
  v_mfma_f32_16x16x32_bf16 v[32:35], v[144:147], v[16:19], 0
  v_mfma_f32_16x16x32_bf16 v[32:35], v[148:151], v[20:23], v[32:35]
  v_mfma_f32_16x16x32_bf16 v[32:35], v[152:155], v[24:27], v[32:35]
  v_mfma_f32_16x16x32_bf16 v[32:35], v[156:159], v[164:167], v[32:35]
  s_mov_b32 s47, 1035273459
  s_mov_b32 s48, 1069066811
  v_readfirstlane_b32 s53, v28
  v_cvt_pk_bf16_f32 v9, v8, v9
  v_lshlrev_b32 v8, 16, v9
  v_and_b32 v9, 0xffff0000, v9
  v_mul_f32 v8, s47, v8
  v_mul_f32 v9, s47, v9
  v_cvt_pk_bf16_f32 v9, v8, v9
  v_lshlrev_b32 v8, 16, v9
  v_and_b32 v9, 0xffff0000, v9
  v_cvt_pk_bf16_f32 v11, v10, v11
  v_lshlrev_b32 v10, 16, v11
  v_and_b32 v11, 0xffff0000, v11
  v_mul_f32 v10, s47, v10
  v_mul_f32 v11, s47, v11
  v_cvt_pk_bf16_f32 v11, v10, v11
  v_lshlrev_b32 v10, 16, v11
  v_and_b32 v11, 0xffff0000, v11
  v_cvt_pk_bf16_f32 v13, v12, v13
  v_lshlrev_b32 v12, 16, v13
  v_and_b32 v13, 0xffff0000, v13
  v_mul_f32 v12, s47, v12
  v_mul_f32 v13, s47, v13
  v_cvt_pk_bf16_f32 v13, v12, v13
  v_lshlrev_b32 v12, 16, v13
  v_and_b32 v13, 0xffff0000, v13
  v_cvt_pk_bf16_f32 v15, v14, v15
  v_lshlrev_b32 v14, 16, v15
  v_and_b32 v15, 0xffff0000, v15
  v_mul_f32 v14, s47, v14
  v_mul_f32 v15, s47, v15
  v_cvt_pk_bf16_f32 v15, v14, v15
  v_lshlrev_b32 v14, 16, v15
  v_and_b32 v15, 0xffff0000, v15
  v_cvt_pk_bf16_f32 v161, v160, v161
  v_lshlrev_b32 v160, 16, v161
  v_and_b32 v161, 0xffff0000, v161
  v_mul_f32 v160, s47, v160
  v_mul_f32 v161, s47, v161
  v_cvt_pk_bf16_f32 v161, v160, v161
  v_lshlrev_b32 v160, 16, v161
  v_and_b32 v161, 0xffff0000, v161
  v_cvt_pk_bf16_f32 v163, v162, v163
  v_lshlrev_b32 v162, 16, v163
  v_and_b32 v163, 0xffff0000, v163
  v_mul_f32 v162, s47, v162
  v_mul_f32 v163, s47, v163
  v_cvt_pk_bf16_f32 v163, v162, v163
  v_lshlrev_b32 v162, 16, v163
  v_and_b32 v163, 0xffff0000, v163
  v_cvt_pk_bf16_f32 v33, v32, v33
  v_lshlrev_b32 v32, 16, v33
  v_and_b32 v33, 0xffff0000, v33
  v_mul_f32 v32, s47, v32
  v_mul_f32 v33, s47, v33
  v_cvt_pk_bf16_f32 v33, v32, v33
  v_lshlrev_b32 v32, 16, v33
  v_and_b32 v33, 0xffff0000, v33
  v_cvt_pk_bf16_f32 v35, v34, v35
  v_lshlrev_b32 v34, 16, v35
  v_and_b32 v35, 0xffff0000, v35
  v_mul_f32 v34, s47, v34
  v_mul_f32 v35, s47, v35
  v_cvt_pk_bf16_f32 v35, v34, v35
  v_lshlrev_b32 v34, 16, v35
  v_and_b32 v35, 0xffff0000, v35
  v_max3_f32 v24, v8, v9, v10
  v_max3_f32 v24, v24, v11, v12
  v_max3_f32 v24, v24, v13, v14
  v_max3_f32 v24, v24, v15, v160
  v_max3_f32 v24, v24, v161, v162
  v_max3_f32 v24, v24, v163, v32
  v_max3_f32 v24, v24, v33, v34
  v_max_f32 v24, v24, v35
  v_mov_b32 v25, v24
  s_nop 1
  v_permlane16_swap_b32 v24, v25
  s_nop 0
  v_max_f32 v24, v24, v25
  v_mov_b32 v25, v24
  s_nop 1
  v_permlane32_swap_b32 v24, v25
  s_nop 0
  v_max_f32 v24, v24, v25
  v_mul_f32 v26, s48, v24
  v_fma_f32 v8, v8, s48, -v26
  v_fma_f32 v9, v9, s48, -v26
  v_fma_f32 v10, v10, s48, -v26
  v_fma_f32 v11, v11, s48, -v26
  v_fma_f32 v12, v12, s48, -v26
  v_fma_f32 v13, v13, s48, -v26
  v_fma_f32 v14, v14, s48, -v26
  v_fma_f32 v15, v15, s48, -v26
  v_fma_f32 v160, v160, s48, -v26
  v_fma_f32 v161, v161, s48, -v26
  v_fma_f32 v162, v162, s48, -v26
  v_fma_f32 v163, v163, s48, -v26
  v_fma_f32 v32, v32, s48, -v26
  v_fma_f32 v33, v33, s48, -v26
  v_fma_f32 v34, v34, s48, -v26
  v_fma_f32 v35, v35, s48, -v26
  v_exp_f32 v8, v8
  v_exp_f32 v9, v9
  v_exp_f32 v10, v10
  v_exp_f32 v11, v11
  v_exp_f32 v12, v12
  v_exp_f32 v13, v13
  v_exp_f32 v14, v14
  v_exp_f32 v15, v15
  v_exp_f32 v160, v160
  v_exp_f32 v161, v161
  v_exp_f32 v162, v162
  v_exp_f32 v163, v163
  v_exp_f32 v32, v32
  v_exp_f32 v33, v33
  v_exp_f32 v34, v34
  v_exp_f32 v35, v35
  v_pk_add_f32 v[26:27], v[8:9], v[10:11]
  v_pk_add_f32 v[26:27], v[26:27], v[12:13]
  v_pk_add_f32 v[26:27], v[26:27], v[14:15]
  v_pk_add_f32 v[26:27], v[26:27], v[160:161]
  v_pk_add_f32 v[26:27], v[26:27], v[162:163]
  v_pk_add_f32 v[26:27], v[26:27], v[32:33]
  v_pk_add_f32 v[26:27], v[26:27], v[34:35]
  v_add_f32 v25, v26, v27
  v_cvt_pk_bf16_f32 v16, v8, v9
  v_cvt_pk_bf16_f32 v17, v10, v11
  v_cvt_pk_bf16_f32 v18, v12, v13
  v_cvt_pk_bf16_f32 v19, v14, v15
  v_cvt_pk_bf16_f32 v20, v160, v161
  v_cvt_pk_bf16_f32 v21, v162, v163
  v_cvt_pk_bf16_f32 v22, v32, v33
  v_cvt_pk_bf16_f32 v23, v34, v35
  v_mov_b32 v26, v25
  s_nop 1
  v_permlane16_swap_b32 v25, v26
  s_nop 0
  v_add_f32 v25, v25, v26
  v_mov_b32 v26, v25
  s_nop 1
  v_permlane32_swap_b32 v25, v26
  s_nop 0
  v_add_f32 v25, v25, v26
  s_lshl_b32 s49, s57, 3
  s_add_u32 s49, s49, 132096
  v_lshl_add_u32 v27, v30, 6, s49
  v_min_u32 v25, -2, v25
  ds_write_b64 v27, v[24:25]
  s_mov_b32 vcc_lo, 0xf000f
  s_mov_b32 vcc_hi, vcc_lo
  v_cndmask_b32 v32, 0, v16, vcc
  v_cndmask_b32 v33, 0, v17, vcc
  v_cndmask_b32 v34, 0, v18, vcc
  v_cndmask_b32 v35, 0, v19, vcc
  v_cndmask_b32 v48, 0, v20, vcc
  v_cndmask_b32 v49, 0, v21, vcc
  v_cndmask_b32 v50, 0, v22, vcc
  v_cndmask_b32 v51, 0, v23, vcc
  s_mov_b32 vcc_lo, 0xf000f0
  s_mov_b32 vcc_hi, vcc_lo
  v_cndmask_b32 v36, 0, v16, vcc
  v_cndmask_b32 v37, 0, v17, vcc
  v_cndmask_b32 v38, 0, v18, vcc
  v_cndmask_b32 v39, 0, v19, vcc
  v_cndmask_b32 v52, 0, v20, vcc
  v_cndmask_b32 v53, 0, v21, vcc
  v_cndmask_b32 v54, 0, v22, vcc
  v_cndmask_b32 v55, 0, v23, vcc
  s_mov_b32 vcc_lo, 0xf000f00
  s_mov_b32 vcc_hi, vcc_lo
  v_cndmask_b32 v40, 0, v16, vcc
  v_cndmask_b32 v41, 0, v17, vcc
  v_cndmask_b32 v42, 0, v18, vcc
  v_cndmask_b32 v43, 0, v19, vcc
  v_cndmask_b32 v56, 0, v20, vcc
  v_cndmask_b32 v57, 0, v21, vcc
  v_cndmask_b32 v58, 0, v22, vcc
  v_cndmask_b32 v59, 0, v23, vcc
  s_mov_b32 vcc_lo, 0xf000f000
  s_mov_b32 vcc_hi, vcc_lo
  v_cndmask_b32 v44, 0, v16, vcc
  v_cndmask_b32 v45, 0, v17, vcc
  v_cndmask_b32 v46, 0, v18, vcc
  v_cndmask_b32 v47, 0, v19, vcc
  v_cndmask_b32 v60, 0, v20, vcc
  v_cndmask_b32 v61, 0, v21, vcc
  v_cndmask_b32 v62, 0, v22, vcc
  v_cndmask_b32 v63, 0, v23, vcc
  s_mov_b32 s52, 1
  s_setpc_b64 s[54:55]
L_pv:
  v_mul_u32_u24 v1, 40, v7
  v_lshl_add_u32 v1, v6, 2, v1
  v_add_u32 v1, s51, v1
  v_add_u32 v2, 1280, v1
  s_waitcnt vmcnt(14)
  v_perm_b32 v128, v68, v64, s60
  v_perm_b32 v132, v68, v64, s61
  v_perm_b32 v136, v69, v65, s60
  v_perm_b32 v140, v69, v65, s61
  v_perm_b32 v144, v70, v66, s60
  v_perm_b32 v148, v70, v66, s61
  v_perm_b32 v152, v71, v67, s60
  v_perm_b32 v156, v71, v67, s61
  s_waitcnt vmcnt(12)
  v_perm_b32 v129, v76, v72, s60
  v_perm_b32 v133, v76, v72, s61
  v_perm_b32 v137, v77, v73, s60
  v_perm_b32 v141, v77, v73, s61
  v_perm_b32 v145, v78, v74, s60
  v_perm_b32 v149, v78, v74, s61
  v_perm_b32 v153, v79, v75, s60
  v_perm_b32 v157, v79, v75, s61
  s_waitcnt vmcnt(10)
  v_perm_b32 v130, v84, v80, s60
  v_perm_b32 v134, v84, v80, s61
  v_perm_b32 v138, v85, v81, s60
  v_perm_b32 v142, v85, v81, s61
  v_perm_b32 v146, v86, v82, s60
  v_perm_b32 v150, v86, v82, s61
  v_perm_b32 v154, v87, v83, s60
  v_perm_b32 v158, v87, v83, s61
  s_waitcnt vmcnt(8)
  v_perm_b32 v131, v92, v88, s60
  v_perm_b32 v135, v92, v88, s61
  v_perm_b32 v139, v93, v89, s60
  v_mfma_f32_16x16x32_bf16 v[16:19], v[32:35], v[128:131], 0
  v_perm_b32 v143, v93, v89, s61
  v_mfma_f32_16x16x32_bf16 v[16:19], v[36:39], v[132:135], v[16:19]
  v_perm_b32 v147, v94, v90, s60
  v_mfma_f32_16x16x32_bf16 v[16:19], v[40:43], v[136:139], v[16:19]
  v_perm_b32 v151, v94, v90, s61
  v_mfma_f32_16x16x32_bf16 v[16:19], v[44:47], v[140:143], v[16:19]
  v_perm_b32 v155, v95, v91, s60
  v_mfma_f32_16x16x32_bf16 v[20:23], v[32:35], v[144:147], 0
  v_perm_b32 v159, v95, v91, s61
  v_mfma_f32_16x16x32_bf16 v[20:23], v[36:39], v[148:151], v[20:23]
  s_nop 0
  v_mfma_f32_16x16x32_bf16 v[20:23], v[40:43], v[152:155], v[20:23]
  v_mfma_f32_16x16x32_bf16 v[20:23], v[44:47], v[156:159], v[20:23]
  s_waitcnt vmcnt(6)
  v_perm_b32 v128, v100, v96, s60
  v_perm_b32 v132, v100, v96, s61
  v_perm_b32 v136, v101, v97, s60
  v_perm_b32 v140, v101, v97, s61
  v_perm_b32 v144, v102, v98, s60
  v_perm_b32 v148, v102, v98, s61
  v_perm_b32 v152, v103, v99, s60
  v_perm_b32 v156, v103, v99, s61
  s_waitcnt vmcnt(4)
  v_perm_b32 v129, v108, v104, s60
  v_perm_b32 v133, v108, v104, s61
  v_perm_b32 v137, v109, v105, s60
  v_perm_b32 v141, v109, v105, s61
  v_perm_b32 v145, v110, v106, s60
  v_perm_b32 v149, v110, v106, s61
  v_perm_b32 v153, v111, v107, s60
  v_perm_b32 v157, v111, v107, s61
  s_waitcnt vmcnt(2)
  v_perm_b32 v130, v116, v112, s60
  v_perm_b32 v134, v116, v112, s61
  v_perm_b32 v138, v117, v113, s60
  v_perm_b32 v142, v117, v113, s61
  v_perm_b32 v146, v118, v114, s60
  v_perm_b32 v150, v118, v114, s61
  v_perm_b32 v154, v119, v115, s60
  v_perm_b32 v158, v119, v115, s61
  s_setprio 3
  s_waitcnt vmcnt(0)
  v_perm_b32 v131, v124, v120, s60
  v_perm_b32 v135, v124, v120, s61
  v_perm_b32 v139, v125, v121, s60
  v_mfma_f32_16x16x32_bf16 v[16:19], v[48:51], v[128:131], v[16:19]
  v_perm_b32 v143, v125, v121, s61
  v_mfma_f32_16x16x32_bf16 v[16:19], v[52:55], v[132:135], v[16:19]
  v_perm_b32 v147, v126, v122, s60
  v_mfma_f32_16x16x32_bf16 v[16:19], v[56:59], v[136:139], v[16:19]
  v_perm_b32 v151, v126, v122, s61
  v_mfma_f32_16x16x32_bf16 v[16:19], v[60:63], v[140:143], v[16:19]
  v_perm_b32 v155, v127, v123, s60
  v_mfma_f32_16x16x32_bf16 v[20:23], v[48:51], v[144:147], v[20:23]
  v_perm_b32 v159, v127, v123, s61
  v_mfma_f32_16x16x32_bf16 v[20:23], v[52:55], v[148:151], v[20:23]
  s_nop 0
  v_mfma_f32_16x16x32_bf16 v[20:23], v[56:59], v[152:155], v[20:23]
  v_mfma_f32_16x16x32_bf16 v[20:23], v[60:63], v[156:159], v[20:23]
  s_cmp_ge_u32 s57, 4
  ds_write2_b32 v1, v16, v17 offset0:0 offset1:160
  ds_write2_b32 v2, v18, v19 offset0:0 offset1:160
  s_nop 4
  ds_write2_b32 v1, v20, v21 offset0:4 offset1:164
  ds_write2_b32 v2, v22, v23 offset0:4 offset1:164
  s_cbranch_scc1 L_odone
  s_setprio 1
  s_mul_i32 s49, s57, 640
  s_add_u32 s49, s49, 137984
  v_lshrrev_b32 v4, 2, v0
  v_mul_u32_u24 v4, 40, v4
  v_lshl_add_u32 v4, v30, 3, v4
  v_add_u32 v4, s49, v4
  v_lshlrev_b32 v3, 12, v6
  v_bfe_u32 v8, v0, 1, 3
  v_lshl_add_u32 v3, v8, 8, v3
  v_and_b32 v8, 9, v0
  v_lshl_add_u32 v3, v8, 3, v3
  s_bfe_u32 s49, s31, 0x10002
  s_lshl_b32 s49, s49, 10
  v_xor_b32 v3, s49, v3
  s_lshl_b32 s50, s30, 16
  s_lshl_b32 s49, s57, 14
  s_add_u32 s50, s50, s49
  s_bfe_u32 s49, s31, 0x10003
  s_lshl_b32 s49, s49, 11
  s_add_u32 s50, s50, s49
  s_lshr_b32 s49, s31, 4
  s_lshl_b32 s49, s49, 7
  s_add_u32 s50, s50, s49
  s_and_b32 s49, s31, 3
  s_lshl_b32 s49, s49, 4
  s_add_u32 s50, s50, s49
  s_add_u32 s50, s50, 524288
  s_lshl_b32 s49, s57, 5
  s_add_u32 s49, s49, 132352
  v_mov_b32 v28, s49
  s_mov_b32 s48, 64
L_bf:
  ds_read_b128 v[160:163], v28
  ds_read_b128 v[164:167], v28 offset:16
  ds_read_b64 v[8:9], v4 offset:0
  ds_read_b64 v[10:11], v4 offset:2560
  ds_read_b64 v[12:13], v4 offset:5120
  ds_read_b64 v[14:15], v4 offset:7680
  s_waitcnt lgkmcnt(0)
  v_max3_u32 v29, v8, v9, v10
  v_max3_u32 v29, v29, v11, v12
  v_max3_u32 v29, v29, v13, v14
  v_max3_u32 v29, v29, v15, v160
  v_cmp_eq_u32 vcc, -1, v29
  s_cmp_eq_u64 vcc, 0
  s_cbranch_scc1 L_bf_ok
  s_sleep 2
  s_sub_u32 s62, s62, 1
  s_cbranch_scc0 L_bf
  s_mov_b32 s62, 0
L_bf_ok:
  v_pk_mul_f32 v[26:27], v[8:9], v[160:161] op_sel:[0,0] op_sel_hi:[1,0]
  v_pk_fma_f32 v[26:27], v[10:11], v[160:161], v[26:27] op_sel:[0,1,0] op_sel_hi:[1,1,1]
  v_pk_fma_f32 v[26:27], v[12:13], v[162:163], v[26:27] op_sel:[0,0,0] op_sel_hi:[1,0,1]
  v_pk_fma_f32 v[26:27], v[14:15], v[162:163], v[26:27] op_sel:[0,1,0] op_sel_hi:[1,1,1]
L_bo_r:
  s_sub_u32 s48, s48, 1
  s_cbranch_scc1 L_bo_chk
L_bo:
  ds_read_b64 v[8:9], v4 offset:10240
  ds_read_b64 v[10:11], v4 offset:12800
  ds_read_b64 v[12:13], v4 offset:15360
  ds_read_b64 v[14:15], v4 offset:17920
  s_cmp_eq_u32 s53, 0
  s_waitcnt lgkmcnt(0)
  v_pk_fma_f32 v[24:25], v[8:9], v[164:165], v[26:27] op_sel:[0,0,0] op_sel_hi:[1,0,1]
  v_pk_fma_f32 v[24:25], v[10:11], v[164:165], v[24:25] op_sel:[0,1,0] op_sel_hi:[1,1,1]
  v_pk_fma_f32 v[24:25], v[12:13], v[166:167], v[24:25] op_sel:[0,0,0] op_sel_hi:[1,0,1]
  v_pk_fma_f32 v[24:25], v[14:15], v[166:167], v[24:25] op_sel:[0,1,0] op_sel_hi:[1,1,1]
  v_cmp_u_f32 vcc, v24, v25
  v_and_or_b32 v24, v24, s63, v5
  v_and_or_b32 v25, v25, s63, v5
  s_cbranch_vccnz L_bo_r
L_bo_ok:
  s_cbranch_scc1 L_oslow
  buffer_store_dwordx2 v[24:25], v3, s[40:43], s50 offen
L_odone:
  s_cmp_lt_u32 s31, 24
  s_cbranch_scc1 L_end
  s_lshl_b32 s52, s30, 3
  s_add_u32 s52, s52, s31
  s_lshl_b32 s52, s52, 6
  s_lshl_b32 s51, s57, 16
  s_add_u32 s50, s52, s51
  s_add_u32 s50, s50, 1047040
  s_mul_i32 s49, s57, 28672
  s_add_u32 s52, s52, s49
  s_add_u32 s52, s52, 1571328
  v_lshrrev_b32 v2, 2, v0
  v_lshlrev_b32 v2, 12, v2
  v_lshl_add_u32 v2, v30, 4, v2
  v_cmp_gt_u32 vcc, 28, v0
  v_mov_b32 v1, 0x20000000
  v_and_b32 v3, 7, v0
  s_lshl_b32 s49, s57, 7
  s_add_u32 s49, s49, 136704
  v_cndmask_b32 v1, v1, v2, vcc
  v_cndmask_b32 v18, 0, v5, vcc
  v_lshlrev_b32 v3, 4, v3
  v_lshl_add_u32 v3, v6, 2, v3
  v_add_u32 v3, s49, v3
  v_and_b32 v4, 1, v0
  v_lshlrev_b32 v4, 2, v4
  v_add_u32 v4, 132576, v4
  s_setprio 0
L_hw:
  ds_read_b32 v28, v4
  s_waitcnt lgkmcnt(0)
  v_cmp_eq_u32 vcc, -1, v28
  s_cmp_eq_u64 vcc, 0
  s_cbranch_scc1 L_hw_ok
  s_sleep 2
  s_sub_u32 s62, s62, 1
  s_cbranch_scc0 L_hw
  s_mov_b32 s62, 0
L_hw_ok:
  s_setprio 2
  s_sleep 5
  buffer_load_dwordx4 v[32:35], v1, s[40:43], s52 offen sc1
  buffer_load_dwordx4 v[36:39], v2, s[40:43], s50 offen sc1
  s_sleep 3
  buffer_load_dwordx4 v[40:43], v1, s[40:43], s52 offen sc1
  buffer_load_dwordx4 v[44:47], v2, s[40:43], s50 offen sc1
  s_branch L_sg
L_sg_r:
  s_cmp_eq_u32 s62, 0
  s_cbranch_scc1 L_sg_ok
  s_sub_u32 s62, s62, 1
  buffer_load_dwordx4 v[40:43], v1, s[40:43], s52 offen sc1
  buffer_load_dwordx4 v[44:47], v2, s[40:43], s50 offen sc1
L_sg:
  s_waitcnt vmcnt(3)
  v_xor_b32 v20, v18, v32
  v_xor_b32 v21, v18, v33
  v_xor_b32 v22, v18, v34
  v_xor_b32 v23, v18, v35
  v_or3_b32 v19, v20, v21, v22
  v_or_b32 v19, v19, v23
  s_waitcnt vmcnt(2)
  v_xor_b32 v24, v5, v36
  v_xor_b32 v25, v5, v37
  v_xor_b32 v26, v5, v38
  v_xor_b32 v27, v5, v39
  v_or3_b32 v19, v19, v24, v25
  v_or3_b32 v19, v19, v26, v27
  v_and_b32 v19, 0xfff, v19
  v_cmp_ne_u32 vcc, 0, v19
  s_wqm_b64 exec, vcc
  s_cbranch_scc0 L_sg_ok
  buffer_load_dwordx4 v[32:35], v1, s[40:43], s52 offen sc1
  buffer_load_dwordx4 v[36:39], v2, s[40:43], s50 offen sc1
  s_waitcnt vmcnt(3)
  v_xor_b32 v20, v18, v40
  v_xor_b32 v21, v18, v41
  v_xor_b32 v22, v18, v42
  v_xor_b32 v23, v18, v43
  v_or3_b32 v19, v20, v21, v22
  v_or_b32 v19, v19, v23
  s_waitcnt vmcnt(2)
  v_xor_b32 v24, v5, v44
  v_xor_b32 v25, v5, v45
  v_xor_b32 v26, v5, v46
  v_xor_b32 v27, v5, v47
  v_or3_b32 v19, v19, v24, v25
  v_or3_b32 v19, v19, v26, v27
  v_and_b32 v19, 0xfff, v19
  v_cmp_ne_u32 vcc, 0, v19
  s_wqm_b64 exec, vcc
  s_cbranch_scc1 L_sg_r
L_sg_ok:
  s_mov_b64 exec, -1
  v_permlane32_swap_b32 v20, v22
  v_permlane32_swap_b32 v21, v23
  v_permlane32_swap_b32 v24, v26
  v_permlane32_swap_b32 v25, v27
  v_pk_add_f32 v[20:21], v[20:21], v[22:23]
  v_pk_add_f32 v[24:25], v[24:25], v[26:27]
  s_nop 0
  v_permlane16_swap_b32 v20, v21
  v_permlane16_swap_b32 v24, v25
  v_add_f32 v20, v20, v21
  v_add_f32 v25, v24, v25
  s_nop 0
  v_add_f32_dpp v24, v20, v20 row_ror:4 row_mask:0xf bank_mask:0xa
  v_add_f32_dpp v24, v25, v25 row_ror:4 row_mask:0xf bank_mask:0x5
  s_nop 1
  v_add_f32_dpp v24, v24, v24 row_ror:8 row_mask:0xf bank_mask:0xf
  ds_write_b32 v3, v24
  s_waitcnt lgkmcnt(0)
  s_barrier
  s_endpgm
L_bo_chk:
  v_max3_u32 v29, v8, v9, v10
  v_max3_u32 v29, v29, v11, v12
  v_max3_u32 v29, v29, v13, v14
  v_max_u32 v29, v29, v15
  v_cmp_eq_u32 vcc, -1, v29
  s_mov_b32 s48, 64
  s_cmp_eq_u64 vcc, 0
  s_cbranch_scc1 L_bo_go
  s_sub_u32 s62, s62, 64
  s_cbranch_scc0 L_bo
  s_mov_b32 s62, 0
L_bo_go:
  s_cmp_eq_u32 s53, 0
  s_branch L_bo_ok
L_oslow:
  s_lshl_b32 s50, s30, 5
  s_add_u32 s50, s50, s31
  s_lshl_b32 s50, s50, 2
  s_add_u32 s50, s50, s57
  s_lshl_b32 s50, s50, 9
  s_add_u32 s50, s50, 524288
  v_lshlrev_b32 v3, 3, v0
  buffer_store_dwordx2 v[24:25], v3, s[40:43], s50 offen sc1
  s_branch L_odone
L_svc2:
  s_waitcnt lgkmcnt(0)
  s_mov_b32 s60, 0x05040100
  s_mov_b32 s61, 0x07060302
  s_mov_b32 s62, 0x200000
  s_mov_b32 s63, 0xfffff000
  s_mov_b64 s[40:41], s[28:29]
  s_mov_b32 s42, 0x10000000
  s_mov_b32 s43, 0x20000
  v_lshrrev_b32 v30, 1, v6
  v_lshlrev_b32 v30, 11, v30
  v_and_b32 v4, 31, v0
  v_lshl_add_u32 v30, v4, 4, v30
  v_mov_b32 v29, 137732
  s_cmp_eq_u32 s3, 1
  s_cbranch_scc1 L_q2
  s_cmp_ge_u32 s31, 28
  s_cbranch_scc1 L_wo
  s_bitcmp1_b32 s30, 0
  s_cbranch_scc1 L_wo
  s_mov_b32 s51, s48
  s_lshl_b32 s53, s49, 11
  s_lshl_b32 s50, s48, 9
  s_add_u32 s53, s53, s50
  s_add_u32 s53, s53, 262144
  s_add_u32 s54, s53, 16
  s_mov_b32 s55, 8
  s_mov_b32 s56, 5
  s_mov_b32 s57, 134656
  s_branch L_gemv
L_q2:
  s_lshl_b32 s53, s30, 14
  s_lshl_b32 s50, s51, 11
  s_add_u32 s53, s53, s50
  s_lshl_b32 s50, s47, 7
  s_add_u32 s53, s53, s50
  s_add_u32 s53, s53, 65536
  s_add_u32 s54, s53, 1024
  s_mov_b32 s55, 13
  s_mov_b32 s56, 4
  s_mov_b32 s57, 132608
L_gemv:
  s_lshl_b32 s50, s51, 8
  s_add_u32 s47, s57, s50
  v_lshrrev_b32 v3, 3, v7
  v_lshlrev_b32 v3, 10, v3
  v_lshl_add_u32 v3, v6, 6, v3
  v_and_b32 v4, 1, v0
  v_lshl_add_u32 v3, v4, 5, v3
  v_add_u32 v3, s47, v3
  v_lshrrev_b32 v4, 5, v0
  v_lshlrev_b32 v4, s55, v4
  v_lshlrev_b32 v2, s56, v2
  v_add_u32 v4, v4, v2
  s_waitcnt vmcnt(8)
  v_perm_b32 v128, v68, v64, s60
  v_perm_b32 v132, v68, v64, s61
  v_perm_b32 v136, v69, v65, s60
  v_perm_b32 v140, v69, v65, s61
  v_perm_b32 v144, v70, v66, s60
  v_perm_b32 v148, v70, v66, s61
  v_perm_b32 v152, v71, v67, s60
  v_perm_b32 v156, v71, v67, s61
  v_perm_b32 v129, v76, v72, s60
  v_perm_b32 v133, v76, v72, s61
  v_perm_b32 v137, v77, v73, s60
  v_perm_b32 v141, v77, v73, s61
  v_perm_b32 v145, v78, v74, s60
  v_perm_b32 v149, v78, v74, s61
  v_perm_b32 v153, v79, v75, s60
  v_perm_b32 v157, v79, v75, s61
  v_perm_b32 v130, v84, v80, s60
  v_perm_b32 v134, v84, v80, s61
  v_perm_b32 v138, v85, v81, s60
  v_perm_b32 v142, v85, v81, s61
  v_perm_b32 v146, v86, v82, s60
  v_perm_b32 v150, v86, v82, s61
  v_perm_b32 v154, v87, v83, s60
  v_perm_b32 v158, v87, v83, s61
  v_perm_b32 v131, v92, v88, s60
  v_perm_b32 v135, v92, v88, s61
  v_perm_b32 v139, v93, v89, s60
  v_perm_b32 v143, v93, v89, s61
  v_perm_b32 v147, v94, v90, s60
  v_perm_b32 v151, v94, v90, s61
  v_perm_b32 v155, v95, v91, s60
  v_perm_b32 v159, v95, v91, s61
  s_waitcnt vmcnt(0)
  v_perm_b32 v64, v100, v96, s60
  v_perm_b32 v68, v100, v96, s61
  v_perm_b32 v72, v101, v97, s60
  v_perm_b32 v76, v101, v97, s61
  v_perm_b32 v80, v102, v98, s60
  v_perm_b32 v84, v102, v98, s61
  v_perm_b32 v88, v103, v99, s60
  v_perm_b32 v92, v103, v99, s61
  v_perm_b32 v65, v108, v104, s60
  v_perm_b32 v69, v108, v104, s61
  v_perm_b32 v73, v109, v105, s60
  v_perm_b32 v77, v109, v105, s61
  v_perm_b32 v81, v110, v106, s60
  v_perm_b32 v85, v110, v106, s61
  v_perm_b32 v89, v111, v107, s60
  v_perm_b32 v93, v111, v107, s61
  v_perm_b32 v66, v116, v112, s60
  v_perm_b32 v70, v116, v112, s61
  v_perm_b32 v74, v117, v113, s60
  v_perm_b32 v78, v117, v113, s61
  v_perm_b32 v82, v118, v114, s60
  v_perm_b32 v86, v118, v114, s61
  v_perm_b32 v90, v119, v115, s60
  v_perm_b32 v94, v119, v115, s61
  v_perm_b32 v67, v124, v120, s60
  v_perm_b32 v71, v124, v120, s61
  v_perm_b32 v75, v125, v121, s60
  v_perm_b32 v79, v125, v121, s61
  v_perm_b32 v83, v126, v122, s60
  v_perm_b32 v87, v126, v122, s61
  v_perm_b32 v91, v127, v123, s60
  v_perm_b32 v95, v127, v123, s61
L_xa:
  ds_read_b128 v[8:11], v3
  ds_read_b128 v[12:15], v3 offset:16
  ds_read_b32 v5, v29
  s_waitcnt lgkmcnt(0)
  v_max3_u32 v16, v8, v11, v12
  v_max_u32 v16, v16, v15
  v_cmp_eq_u32 vcc, -1, v16
  s_cmp_eq_u64 vcc, 0
  s_cbranch_scc1 L_xa_ok
  s_sleep 1
  s_sub_u32 s62, s62, 1
  s_cbranch_scc0 L_xa
  s_mov_b32 s62, 0
L_xa_ok:
  v_mfma_f32_16x16x32_bf16 v[32:35], v[8:11], v[128:131], 0
  v_mfma_f32_16x16x32_bf16 v[36:39], v[8:11], v[132:135], 0
  v_mfma_f32_16x16x32_bf16 v[40:43], v[8:11], v[136:139], 0
  v_mfma_f32_16x16x32_bf16 v[44:47], v[8:11], v[140:143], 0
  v_mfma_f32_16x16x32_bf16 v[48:51], v[8:11], v[144:147], 0
  v_mfma_f32_16x16x32_bf16 v[52:55], v[8:11], v[148:151], 0
  v_mfma_f32_16x16x32_bf16 v[56:59], v[8:11], v[152:155], 0
  v_mfma_f32_16x16x32_bf16 v[60:63], v[8:11], v[156:159], 0
  v_mfma_f32_16x16x32_bf16 v[32:35], v[12:15], v[64:67], v[32:35]
  v_mfma_f32_16x16x32_bf16 v[36:39], v[12:15], v[68:71], v[36:39]
  v_mfma_f32_16x16x32_bf16 v[40:43], v[12:15], v[72:75], v[40:43]
  v_mfma_f32_16x16x32_bf16 v[44:47], v[12:15], v[76:79], v[44:47]
  v_mfma_f32_16x16x32_bf16 v[48:51], v[12:15], v[80:83], v[48:51]
  v_mfma_f32_16x16x32_bf16 v[52:55], v[12:15], v[84:87], v[52:55]
  v_mfma_f32_16x16x32_bf16 v[56:59], v[12:15], v[88:91], v[56:59]
  v_mfma_f32_16x16x32_bf16 v[60:63], v[12:15], v[92:95], v[60:63]
  s_nop 1
  v_add_f32_dpp v16, v33, v32 row_ror:8 row_mask:0xf bank_mask:0xf
  v_add_f32_dpp v17, v37, v36 row_ror:8 row_mask:0xf bank_mask:0xf
  v_add_f32_dpp v18, v41, v40 row_ror:8 row_mask:0xf bank_mask:0xf
  v_add_f32_dpp v19, v45, v44 row_ror:8 row_mask:0xf bank_mask:0xf
  v_add_f32_dpp v20, v49, v48 row_ror:8 row_mask:0xf bank_mask:0xf
  v_add_f32_dpp v21, v53, v52 row_ror:8 row_mask:0xf bank_mask:0xf
  v_add_f32_dpp v22, v57, v56 row_ror:8 row_mask:0xf bank_mask:0xf
  v_add_f32_dpp v23, v61, v60 row_ror:8 row_mask:0xf bank_mask:0xf
  v_and_b32 v28, 0xff, v5
  s_movk_i32 s55, 0xff00
  v_and_or_b32 v16, v16, s55, v28
  v_and_or_b32 v17, v17, s55, v28
  v_and_or_b32 v18, v18, s55, v28
  v_and_or_b32 v19, v19, s55, v28
  v_and_or_b32 v20, v20, s55, v28
  v_and_or_b32 v21, v21, s55, v28
  v_and_or_b32 v22, v22, s55, v28
  v_and_or_b32 v23, v23, s55, v28
  s_mov_b32 exec_lo, 0xff
  s_mov_b32 exec_hi, 0xff
  buffer_store_dwordx4 v[16:19], v4, s[40:43], s53 offen sc1
  buffer_store_dwordx4 v[20:23], v4, s[40:43], s54 offen sc1
  s_mov_b64 exec, -1
  s_cmp_lg_u32 s3, 1
  s_cbranch_scc1 L_wo
  s_lshl_b32 s47, s30, 1
  s_lshr_b32 s48, s31, 4
  s_add_u32 s47, s47, s48
  s_lshl_b32 s49, s47, 13
  s_add_u32 s49, s49, 65536
  s_add_u32 s50, s49, 4096
  v_lshlrev_b32 v2, 4, v0
  v_add_u32 v3, 131072, v2
  v_and_b32 v4, 0x1f0, v2
  s_getreg_b32 s51, hwreg(HW_REG_XCC_ID, 0, 4)
  s_lshl_b32 s51, s51, 12
  s_lshl_b32 s52, s30, 9
  s_add_u32 s52, s52, 319488
  s_lshl_b32 s53, s31, 4
  s_add_u32 s53, s53, s52
  v_or_b32 v24, s51, v5
  v_mov_b32 v25, v5
  v_mov_b32 v26, v5
  v_mov_b32 v27, v5
  s_mov_b64 exec, 1
  buffer_store_dwordx4 v[24:27], v2, s[40:43], s53 offen sc1
  s_mov_b64 exec, -1
  v_and_b32 v9, 7, v0
  v_lshlrev_b32 v9, 2, v9
  v_add_u32 v9, 132544, v9
L_kw:
  ds_read_b32 v8, v9
  s_waitcnt lgkmcnt(0)
  v_cmp_eq_u32 vcc, -1, v8
  s_cmp_eq_u64 vcc, 0
  s_cbranch_scc1 L_kw_ok
  s_sleep 4
  s_sub_u32 s62, s62, 1
  s_cbranch_scc0 L_kw
  s_mov_b32 s62, 0
L_kw_ok:
L_q:
  buffer_load_dwordx4 v[32:35], v2, s[40:43], s49 offen offset:0 sc1
  buffer_load_dwordx4 v[36:39], v2, s[40:43], s49 offen offset:1024 sc1
  buffer_load_dwordx4 v[40:43], v2, s[40:43], s49 offen offset:2048 sc1
  buffer_load_dwordx4 v[44:47], v2, s[40:43], s49 offen offset:3072 sc1
  buffer_load_dwordx4 v[48:51], v2, s[40:43], s50 offen offset:0 sc1
  buffer_load_dwordx4 v[52:55], v2, s[40:43], s50 offen offset:1024 sc1
  buffer_load_dwordx4 v[56:59], v2, s[40:43], s50 offen offset:2048 sc1
  buffer_load_dwordx4 v[60:63], v2, s[40:43], s50 offen offset:3072 sc1
  buffer_load_dwordx4 v[64:67], v4, s[40:43], s52 offen sc1
L_q_w:
  s_waitcnt vmcnt(0)
  v_xor_b32 v32, v28, v32
  v_xor_b32 v33, v28, v33
  v_xor_b32 v34, v28, v34
  v_xor_b32 v35, v28, v35
  v_xor_b32 v36, v28, v36
  v_xor_b32 v37, v28, v37
  v_xor_b32 v38, v28, v38
  v_xor_b32 v39, v28, v39
  v_xor_b32 v40, v28, v40
  v_xor_b32 v41, v28, v41
  v_xor_b32 v42, v28, v42
  v_xor_b32 v43, v28, v43
  v_xor_b32 v44, v28, v44
  v_xor_b32 v45, v28, v45
  v_xor_b32 v46, v28, v46
  v_xor_b32 v47, v28, v47
  v_xor_b32 v48, v28, v48
  v_xor_b32 v49, v28, v49
  v_xor_b32 v50, v28, v50
  v_xor_b32 v51, v28, v51
  v_xor_b32 v52, v28, v52
  v_xor_b32 v53, v28, v53
  v_xor_b32 v54, v28, v54
  v_xor_b32 v55, v28, v55
  v_xor_b32 v56, v28, v56
  v_xor_b32 v57, v28, v57
  v_xor_b32 v58, v28, v58
  v_xor_b32 v59, v28, v59
  v_xor_b32 v60, v28, v60
  v_xor_b32 v61, v28, v61
  v_xor_b32 v62, v28, v62
  v_xor_b32 v63, v28, v63
  v_xor_b32 v64, v5, v64
  v_xor_b32 v65, v5, v65
  v_xor_b32 v66, v5, v66
  v_xor_b32 v67, v5, v67
  v_or3_b32 v8, v32, v33, v34
  v_or3_b32 v8, v8, v35, v36
  v_or3_b32 v8, v8, v37, v38
  v_or3_b32 v8, v8, v39, v40
  v_or3_b32 v8, v8, v41, v42
  v_or3_b32 v8, v8, v43, v44
  v_or3_b32 v8, v8, v45, v46
  v_or3_b32 v8, v8, v47, v48
  v_or3_b32 v8, v8, v49, v50
  v_or3_b32 v8, v8, v51, v52
  v_or3_b32 v8, v8, v53, v54
  v_or3_b32 v8, v8, v55, v56
  v_or3_b32 v8, v8, v57, v58
  v_or3_b32 v8, v8, v59, v60
  v_or3_b32 v8, v8, v61, v62
  v_or3_b32 v8, v8, v63, v64
  v_and_b32 v8, 0xff, v8
  v_or3_b32 v8, v8, v65, v66
  v_or_b32 v8, v8, v67
  v_cmp_ne_u32 vcc, 0, v8
  s_wqm_b64 exec, vcc
  s_cbranch_scc0 L_q_ok
  s_sleep 8
  s_sub_u32 s62, s62, 1
  s_cbranch_scc0 L_q
  s_mov_b32 s62, 0
L_q_ok:
  s_mov_b64 exec, -1
  v_cmp_ne_u32 vcc, s51, v64
  s_cmp_eq_u64 vcc, 0
  s_cselect_b32 s51, 1, 0
  v_mov_b32 v8, s51
  v_mov_b32 v9, 137728
  ds_write_b32 v9, v8
  v_pk_add_f32 v[32:33], v[32:33], v[40:41]
  v_pk_add_f32 v[48:49], v[48:49], v[56:57]
  v_pk_add_f32 v[34:35], v[34:35], v[42:43]
  v_pk_add_f32 v[50:51], v[50:51], v[58:59]
  v_pk_add_f32 v[36:37], v[36:37], v[44:45]
  v_pk_add_f32 v[52:53], v[52:53], v[60:61]
  v_pk_add_f32 v[38:39], v[38:39], v[46:47]
  v_pk_add_f32 v[54:55], v[54:55], v[62:63]
  v_pk_add_f32 v[32:33], v[32:33], v[48:49]
  v_pk_add_f32 v[34:35], v[34:35], v[50:51]
  v_pk_add_f32 v[36:37], v[36:37], v[52:53]
  v_pk_add_f32 v[38:39], v[38:39], v[54:55]
  v_cvt_pk_bf16_f32 v16, v32, v33
  v_min_u32 v16, -2, v16
  v_cvt_pk_bf16_f32 v17, v34, v35
  v_min_u32 v17, -2, v17
  v_cvt_pk_bf16_f32 v18, v36, v37
  v_min_u32 v18, -2, v18
  v_cvt_pk_bf16_f32 v19, v38, v39
  v_min_u32 v19, -2, v19
  ds_write_b128 v3, v[16:19]
L_wo:
  s_setprio 0
  s_mov_b64 s[36:37], s[12:13]
  s_mov_b32 s38, 0x400000
  s_mov_b32 s39, 0x20000
  s_lshr_b32 s44, s31, 1
  s_lshl_b32 s46, s30, 19
  s_lshl_b32 s47, s44, 15
  s_add_u32 s46, s46, s47
  s_and_b32 s47, s31, 1
  s_lshl_b32 s47, s47, 1
  s_add_u32 s47, s47, s3
  s_sub_u32 s47, s47, 1
  s_lshl_b32 s48, s47, 8
  s_add_u32 s46, s46, s48
  s_add_u32 s48, s46, 16384
  v_lshlrev_b32 v3, 12, v6
  v_lshl_add_u32 v3, v7, 4, v3
  v_lshlrev_b32 v1, 4, v7
  v_lshlrev_b32 v2, 4, v0
  v_and_b32 v4, 7, v0
  v_lshlrev_b32 v4, 2, v4
  v_add_u32 v4, 132352, v4
  s_lshl_b32 s50, s30, 16
  s_lshl_b32 s51, s44, 12
  s_add_u32 s50, s50, s51
  s_add_u32 s50, s50, 524288
  s_lshl_b32 s53, s30, 11
  s_lshr_b32 s54, s44, 2
  s_lshl_b32 s54, s54, 9
  s_add_u32 s53, s53, s54
  s_add_u32 s53, s53, 327680
  s_lshl_b32 s54, s30, 4
  s_add_u32 s54, s54, s44
  s_lshl_b32 s54, s54, 12
  s_lshl_b32 s55, s47, 9
  s_add_u32 s54, s54, s55
  s_add_u32 s54, s54, 1048576
  s_mov_b32 s49, 1069066811
  v_mov_b32 v60, 132584
  v_mov_b32 v61, 137728
L_fw:
  ds_read_b32 v27, v4
  ds_read_b32 v28, v4 offset:160
  ds_read_b32 v5, v29
  ds_read_b32 v26, v61
  s_waitcnt lgkmcnt(0)
  v_max3_u32 v28, v27, v28, v28
  v_cmp_eq_u32 vcc, -1, v28
  s_cmp_eq_u64 vcc, 0
  s_cbranch_scc1 L_fw_ok
  s_sleep 2
  s_sub_u32 s62, s62, 1
  s_cbranch_scc0 L_fw
  s_mov_b32 s62, 0
L_fw_ok:
  s_setprio 3
  v_readfirstlane_b32 s52, v26
  v_add_u32 v62, 1024, v2
  s_add_u32 s51, s50, 2048
  s_cmp_lg_u32 s52, 0
  s_cbranch_scc1 L_ofast
  v_and_b32 v2, 8, v0
  v_add_u32 v2, v2, v7
  v_lshlrev_b32 v2, 11, v2
  v_and_b32 v62, 4, v0
  v_lshl_add_u32 v2, v62, 4, v2
  v_lshl_add_u32 v2, v6, 4, v2
  v_xor_b32 v62, 0x2000, v2
  s_lshl_b32 s50, s30, 16
  s_lshl_b32 s51, s44, 7
  s_add_u32 s50, s50, s51
  s_add_u32 s50, s50, 524288
  s_add_u32 s51, s50, 0x4000
L_ofast:
  buffer_load_dwordx4 v[32:35], v1, s[40:43], s53 offen sc1
  buffer_load_dwordx4 v[36:39], v1, s[40:43], s53 offen offset:256 sc1
  buffer_load_dwordx4 v[8:11], v2, s[40:43], s50 offen sc1
  buffer_load_dwordx4 v[12:15], v62, s[40:43], s50 offen sc1
  buffer_load_dwordx4 v[16:19], v2, s[40:43], s51 offen sc1
  buffer_load_dwordx4 v[20:23], v62, s[40:43], s51 offen sc1
L_vi:
  ds_read_b32 v28, v4 offset:128
  s_waitcnt lgkmcnt(0)
  v_cmp_eq_u32 vcc, -1, v28
  s_cmp_eq_u64 vcc, 0
  s_cbranch_scc1 L_vi_ok
  s_sleep 1
  s_sub_u32 s62, s62, 1
  s_cbranch_scc0 L_vi
  s_mov_b32 s62, 0
L_vi_ok:
  buffer_load_dwordx4 v[64:67], v3, s[36:39], s46 offen offset:0 nt
  buffer_load_dwordx4 v[68:71], v3, s[36:39], s46 offen offset:1024 nt
  buffer_load_dwordx4 v[72:75], v3, s[36:39], s46 offen offset:2048 nt
  buffer_load_dwordx4 v[76:79], v3, s[36:39], s46 offen offset:3072 nt
  buffer_load_dwordx4 v[80:83], v3, s[36:39], s48 offen offset:0 nt
  buffer_load_dwordx4 v[84:87], v3, s[36:39], s48 offen offset:1024 nt
  buffer_load_dwordx4 v[88:91], v3, s[36:39], s48 offen offset:2048 nt
  buffer_load_dwordx4 v[92:95], v3, s[36:39], s48 offen offset:3072 nt
  s_setprio 1
  s_waitcnt vmcnt(12)
  s_branch L_mlc
L_mlr:
  buffer_load_dwordx4 v[32:35], v1, s[40:43], s53 offen sc1
  buffer_load_dwordx4 v[36:39], v1, s[40:43], s53 offen offset:256 sc1
  s_waitcnt vmcnt(0)
L_mlc:
  v_xor_b32 v32, v5, v32
  v_xor_b32 v33, v5, v33
  v_xor_b32 v34, v5, v34
  v_xor_b32 v35, v5, v35
  v_xor_b32 v36, v5, v36
  v_xor_b32 v37, v5, v37
  v_xor_b32 v38, v5, v38
  v_xor_b32 v39, v5, v39
  v_or3_b32 v28, v32, v33, v34
  v_or3_b32 v28, v28, v35, v36
  v_or3_b32 v28, v28, v37, v38
  v_or_b32 v28, v28, v39
  v_and_b32 v28, 0xfff, v28
  v_cmp_ne_u32 vcc, 0, v28
  s_wqm_b64 exec, vcc
  s_cbranch_scc0 L_ml_ok
  s_sleep 1
  s_sub_u32 s62, s62, 1
  s_cbranch_scc0 L_mlr
  s_mov_b32 s62, 0
L_ml_ok:
  s_mov_b64 exec, -1
  v_max_f32 v28, v32, v36
  s_nop 1
  v_max_f32_dpp v28, v28, v28 quad_perm:[1,0,3,2] row_mask:0xf bank_mask:0xf
  s_nop 1
  v_max_f32_dpp v28, v28, v28 quad_perm:[2,3,0,1] row_mask:0xf bank_mask:0xf
  s_nop 1
  v_max_f32_dpp v28, v28, v28 row_half_mirror row_mask:0xf bank_mask:0xf
  v_mul_f32 v28, s49, v28
  v_fma_f32 v24, v32, s49, -v28
  v_fma_f32 v26, v36, s49, -v28
  v_exp_f32 v24, v24
  v_exp_f32 v26, v26
  s_nop 0
  v_mul_f32 v25, v33, v24
  v_fmac_f32 v25, v37, v26
  s_nop 1
  v_add_f32_dpp v25, v25, v25 quad_perm:[1,0,3,2] row_mask:0xf bank_mask:0xf
  s_nop 1
  v_add_f32_dpp v25, v25, v25 quad_perm:[2,3,0,1] row_mask:0xf bank_mask:0xf
  s_nop 1
  v_add_f32_dpp v25, v25, v25 row_half_mirror row_mask:0xf bank_mask:0xf
  v_rcp_f32 v25, v25
  s_nop 0
  v_mul_f32 v24, v24, v25
  v_mul_f32 v26, v26, v25
  s_nop 1
  v_mov_b32_dpp v25, v24 row_shl:4 row_mask:0xf bank_mask:0x5
  v_mov_b32_dpp v25, v24 row_shr:4 row_mask:0xf bank_mask:0xa
  v_mov_b32_dpp v27, v26 row_shl:4 row_mask:0xf bank_mask:0x5
  v_mov_b32_dpp v27, v26 row_shr:4 row_mask:0xf bank_mask:0xa
  s_waitcnt vmcnt(8)
  v_xor_b32 v32, v5, v8
  v_xor_b32 v33, v5, v9
  v_xor_b32 v34, v5, v10
  v_xor_b32 v35, v5, v11
  v_xor_b32 v36, v5, v12
  v_xor_b32 v37, v5, v13
  v_xor_b32 v38, v5, v14
  v_xor_b32 v39, v5, v15
  v_xor_b32 v40, v5, v16
  v_xor_b32 v41, v5, v17
  v_xor_b32 v42, v5, v18
  v_xor_b32 v43, v5, v19
  v_xor_b32 v44, v5, v20
  v_xor_b32 v45, v5, v21
  v_xor_b32 v46, v5, v22
  v_xor_b32 v47, v5, v23
  v_or3_b32 v28, v32, v33, v34
  v_or3_b32 v28, v28, v35, v36
  v_or3_b32 v28, v28, v37, v38
  v_or3_b32 v28, v28, v39, v40
  v_or3_b32 v28, v28, v41, v42
  v_or3_b32 v28, v28, v43, v44
  v_or3_b32 v28, v28, v45, v46
  v_or_b32 v28, v28, v47
  v_and_b32 v28, 0xfff, v28
  v_cmp_ne_u32 vcc, 0, v28
  s_mov_b64 s[66:67], vcc
  v_and_b32 v4, 7, v0
  v_mul_u32_u24 v4, 2560, v4
  v_add_u32 v4, 139920, v4
L_ow:
  ds_read_b32 v28, v4
  s_waitcnt lgkmcnt(0)
  v_cmp_eq_u32 vcc, -1, v28
  s_cmp_eq_u64 vcc, 0
  s_cbranch_scc1 L_ow_ok
  s_sleep 1
  s_sub_u32 s62, s62, 1
  s_cbranch_scc0 L_ow
  s_mov_b32 s62, 0
L_ow_ok:
  s_mov_b64 exec, s[66:67]
  buffer_load_dwordx4 v[8:11], v2, s[40:43], s50 offen sc1
  buffer_load_dwordx4 v[12:15], v62, s[40:43], s50 offen sc1
  buffer_load_dwordx4 v[16:19], v2, s[40:43], s51 offen sc1
  buffer_load_dwordx4 v[20:23], v62, s[40:43], s51 offen sc1
  s_mov_b64 exec, -1
  s_waitcnt vmcnt(4)
  v_perm_b32 v128, v68, v64, s60
  v_perm_b32 v132, v68, v64, s61
  v_perm_b32 v136, v69, v65, s60
  v_perm_b32 v140, v69, v65, s61
  v_perm_b32 v144, v70, v66, s60
  v_perm_b32 v148, v70, v66, s61
  v_perm_b32 v152, v71, v67, s60
  v_perm_b32 v156, v71, v67, s61
  v_perm_b32 v129, v76, v72, s60
  v_perm_b32 v133, v76, v72, s61
  v_perm_b32 v137, v77, v73, s60
  v_perm_b32 v141, v77, v73, s61
  v_perm_b32 v145, v78, v74, s60
  v_perm_b32 v149, v78, v74, s61
  v_perm_b32 v153, v79, v75, s60
  v_perm_b32 v157, v79, v75, s61
  v_perm_b32 v130, v84, v80, s60
  v_perm_b32 v134, v84, v80, s61
  v_perm_b32 v138, v85, v81, s60
  v_perm_b32 v142, v85, v81, s61
  v_perm_b32 v146, v86, v82, s60
  v_perm_b32 v150, v86, v82, s61
  v_perm_b32 v154, v87, v83, s60
  v_perm_b32 v158, v87, v83, s61
  v_perm_b32 v131, v92, v88, s60
  v_perm_b32 v135, v92, v88, s61
  v_perm_b32 v139, v93, v89, s60
  v_perm_b32 v143, v93, v89, s61
  v_perm_b32 v147, v94, v90, s60
  v_perm_b32 v151, v94, v90, s61
  v_perm_b32 v155, v95, v91, s60
  v_perm_b32 v159, v95, v91, s61
  s_mov_b64 exec, s[66:67]
  buffer_load_dwordx4 v[96:99], v2, s[40:43], s50 offen sc1
  buffer_load_dwordx4 v[100:103], v62, s[40:43], s50 offen sc1
  buffer_load_dwordx4 v[104:107], v2, s[40:43], s51 offen sc1
  buffer_load_dwordx4 v[108:111], v62, s[40:43], s51 offen sc1
  s_branch L_h1
L_h1_r:
  s_cmp_eq_u32 s62, 0
  s_cbranch_scc1 L_h1_ok
  s_sub_u32 s62, s62, 1
  buffer_load_dwordx4 v[96:99], v2, s[40:43], s50 offen sc1
  buffer_load_dwordx4 v[100:103], v62, s[40:43], s50 offen sc1
  buffer_load_dwordx4 v[104:107], v2, s[40:43], s51 offen sc1
  buffer_load_dwordx4 v[108:111], v62, s[40:43], s51 offen sc1
L_h1:
  s_waitcnt vmcnt(7)
  v_xor_b32 v32, v5, v8
  v_xor_b32 v33, v5, v9
  v_xor_b32 v34, v5, v10
  v_xor_b32 v35, v5, v11
  v_or3_b32 v28, v32, v33, v34
  v_or_b32 v28, v28, v35
  s_waitcnt vmcnt(6)
  v_xor_b32 v36, v5, v12
  v_xor_b32 v37, v5, v13
  v_xor_b32 v38, v5, v14
  v_xor_b32 v39, v5, v15
  v_or3_b32 v28, v28, v36, v37
  v_or3_b32 v28, v28, v38, v39
  s_waitcnt vmcnt(5)
  v_xor_b32 v40, v5, v16
  v_xor_b32 v41, v5, v17
  v_xor_b32 v42, v5, v18
  v_xor_b32 v43, v5, v19
  v_or3_b32 v28, v28, v40, v41
  v_or3_b32 v28, v28, v42, v43
  s_waitcnt vmcnt(4)
  v_xor_b32 v44, v5, v20
  v_xor_b32 v45, v5, v21
  v_xor_b32 v46, v5, v22
  v_xor_b32 v47, v5, v23
  v_or3_b32 v28, v28, v44, v45
  v_or3_b32 v28, v28, v46, v47
  v_and_b32 v28, 0xfff, v28
  v_cmp_ne_u32 vcc, 0, v28
  s_and_b64 exec, exec, vcc
  s_cbranch_scc0 L_h1_ok
  buffer_load_dwordx4 v[8:11], v2, s[40:43], s50 offen sc1
  buffer_load_dwordx4 v[12:15], v62, s[40:43], s50 offen sc1
  buffer_load_dwordx4 v[16:19], v2, s[40:43], s51 offen sc1
  buffer_load_dwordx4 v[20:23], v62, s[40:43], s51 offen sc1
  s_waitcnt vmcnt(7)
  v_xor_b32 v32, v5, v96
  v_xor_b32 v33, v5, v97
  v_xor_b32 v34, v5, v98
  v_xor_b32 v35, v5, v99
  v_or3_b32 v28, v32, v33, v34
  v_or_b32 v28, v28, v35
  s_waitcnt vmcnt(6)
  v_xor_b32 v36, v5, v100
  v_xor_b32 v37, v5, v101
  v_xor_b32 v38, v5, v102
  v_xor_b32 v39, v5, v103
  v_or3_b32 v28, v28, v36, v37
  v_or3_b32 v28, v28, v38, v39
  s_waitcnt vmcnt(5)
  v_xor_b32 v40, v5, v104
  v_xor_b32 v41, v5, v105
  v_xor_b32 v42, v5, v106
  v_xor_b32 v43, v5, v107
  v_or3_b32 v28, v28, v40, v41
  v_or3_b32 v28, v28, v42, v43
  s_waitcnt vmcnt(4)
  v_xor_b32 v44, v5, v108
  v_xor_b32 v45, v5, v109
  v_xor_b32 v46, v5, v110
  v_xor_b32 v47, v5, v111
  v_or3_b32 v28, v28, v44, v45
  v_or3_b32 v28, v28, v46, v47
  v_and_b32 v28, 0xfff, v28
  v_cmp_ne_u32 vcc, 0, v28
  s_and_b64 exec, exec, vcc
  s_cbranch_scc1 L_h1_r
L_h1_ok:
  s_mov_b64 exec, -1
  s_setprio 3
  ds_write_b32 v60, v60
  v_pk_mul_f32 v[32:33], v[32:33], v[24:25] op_sel:[0,0] op_sel_hi:[1,0]
  v_pk_mul_f32 v[34:35], v[34:35], v[24:25] op_sel:[0,0] op_sel_hi:[1,0]
  v_pk_fma_f32 v[32:33], v[36:37], v[24:25], v[32:33] op_sel:[0,1,0] op_sel_hi:[1,1,1]
  v_pk_fma_f32 v[34:35], v[38:39], v[24:25], v[34:35] op_sel:[0,1,0] op_sel_hi:[1,1,1]
  v_pk_fma_f32 v[32:33], v[40:41], v[26:27], v[32:33] op_sel:[0,0,0] op_sel_hi:[1,0,1]
  v_pk_fma_f32 v[34:35], v[42:43], v[26:27], v[34:35] op_sel:[0,0,0] op_sel_hi:[1,0,1]
  v_pk_fma_f32 v[32:33], v[44:45], v[26:27], v[32:33] op_sel:[0,1,0] op_sel_hi:[1,1,1]
  v_pk_fma_f32 v[34:35], v[46:47], v[26:27], v[34:35] op_sel:[0,1,0] op_sel_hi:[1,1,1]
  s_nop 0
  v_add_f32_dpp v32, v32, v32 quad_perm:[1,0,3,2] row_mask:0xf bank_mask:0xf
  v_add_f32_dpp v33, v33, v33 quad_perm:[1,0,3,2] row_mask:0xf bank_mask:0xf
  v_add_f32_dpp v34, v34, v34 quad_perm:[1,0,3,2] row_mask:0xf bank_mask:0xf
  v_add_f32_dpp v35, v35, v35 quad_perm:[1,0,3,2] row_mask:0xf bank_mask:0xf
  v_add_f32_dpp v32, v32, v32 quad_perm:[2,3,0,1] row_mask:0xf bank_mask:0xf
  v_add_f32_dpp v33, v33, v33 quad_perm:[2,3,0,1] row_mask:0xf bank_mask:0xf
  v_add_f32_dpp v34, v34, v34 quad_perm:[2,3,0,1] row_mask:0xf bank_mask:0xf
  v_add_f32_dpp v35, v35, v35 quad_perm:[2,3,0,1] row_mask:0xf bank_mask:0xf
  v_cvt_pk_bf16_f32 v48, v32, v33
  v_cvt_pk_bf16_f32 v49, v34, v35
  s_nop 0
  v_mov_b32_dpp v50, v48 row_shl:4 row_mask:0xf bank_mask:0xf bound_ctrl:0
  v_mov_b32_dpp v51, v49 row_shl:4 row_mask:0xf bank_mask:0xf bound_ctrl:0
  s_nop 1
  v_mfma_f32_16x16x32_bf16 v[64:67], v[48:51], v[128:131], 0
  v_mfma_f32_16x16x32_bf16 v[68:71], v[48:51], v[132:135], 0
  v_mfma_f32_16x16x32_bf16 v[72:75], v[48:51], v[136:139], 0
  v_mfma_f32_16x16x32_bf16 v[76:79], v[48:51], v[140:143], 0
  v_mfma_f32_16x16x32_bf16 v[80:83], v[48:51], v[144:147], 0
  v_mfma_f32_16x16x32_bf16 v[84:87], v[48:51], v[148:151], 0
  v_mfma_f32_16x16x32_bf16 v[88:91], v[48:51], v[152:155], 0
  v_mfma_f32_16x16x32_bf16 v[92:95], v[48:51], v[156:159], 0
  s_mov_b32 exec_lo, 0xffff
  s_mov_b32 exec_hi, 0xffff
  v_and_or_b32 v52, v64, s63, v5
  v_and_or_b32 v53, v68, s63, v5
  v_and_or_b32 v54, v72, s63, v5
  v_and_or_b32 v55, v76, s63, v5
  buffer_store_dwordx4 v[52:55], v30, s[40:43], s54 offen offset:0 sc1
  v_and_or_b32 v56, v80, s63, v5
  v_and_or_b32 v57, v84, s63, v5
  v_and_or_b32 v58, v88, s63, v5
  v_and_or_b32 v59, v92, s63, v5
  buffer_store_dwordx4 v[56:59], v30, s[40:43], s54 offen offset:256 sc1
  s_lshl_b32 s44, s3, 2
  s_add_u32 s44, s44, 132572
  v_mov_b32 v4, s44
  ds_write_b32 v4, v4
  s_endpgm
L_ctl:
  s_mov_b32 s60, 0x05040100
  s_mov_b32 s61, 0x07060302
  s_mov_b32 s62, 0x200000
  s_mov_b32 s63, 0xfffff000
  s_mov_b64 s[40:41], s[28:29]
  s_mov_b32 s42, 0x10000000
  s_mov_b32 s43, 0x20000
  s_mov_b64 s[36:37], s[22:23]
  s_mov_b32 s38, 1024
  s_mov_b32 s39, 0x20000
  s_lshl_b32 s44, s30, 3
  s_and_b32 s45, s31, 7
  s_add_u32 s44, s44, s45
  s_lshl_b32 s45, s30, 8
  s_and_b32 s46, s31, 3
  s_lshl_b32 s46, s46, 6
  s_add_u32 s45, s45, s46
  s_and_b32 s46, s31, 4
  s_lshl_b32 s46, s46, 1
  s_add_u32 s45, s45, s46
  s_and_b32 s46, s45, 1023
  v_add_u32 v4, 132608, v1
  v_and_b32 v1, 3, v0
  v_lshlrev_b32 v1, 4, v1
  v_lshl_add_u32 v58, v6, 2, v1
  v_lshl_add_u32 v1, v6, 1, v1
  v_mov_b32 v3, 137732
  s_mov_b32 s52, 1
  s_waitcnt vmcnt(0)
  v_add_u32 v59, 1, v59
  v_and_b32 v5, 0xfff, v59
  ds_write_b32 v3, v5
L_ln:
  v_lshlrev_b32 v32, 16, v8
  v_and_b32 v33, 0xffff0000, v8
  v_lshlrev_b32 v34, 16, v9
  v_and_b32 v35, 0xffff0000, v9
  v_lshlrev_b32 v36, 16, v10
  v_and_b32 v37, 0xffff0000, v10
  v_lshlrev_b32 v38, 16, v11
  v_and_b32 v39, 0xffff0000, v11
  v_lshlrev_b32 v40, 16, v12
  v_and_b32 v41, 0xffff0000, v12
  v_lshlrev_b32 v42, 16, v13
  v_and_b32 v43, 0xffff0000, v13
  v_lshlrev_b32 v44, 16, v14
  v_and_b32 v45, 0xffff0000, v14
  v_lshlrev_b32 v46, 16, v15
  v_and_b32 v47, 0xffff0000, v15
  v_pk_add_f32 v[20:21], v[32:33], v[34:35]
  v_pk_add_f32 v[22:23], v[36:37], v[38:39]
  v_pk_add_f32 v[24:25], v[40:41], v[42:43]
  v_pk_add_f32 v[26:27], v[44:45], v[46:47]
  v_pk_add_f32 v[20:21], v[20:21], v[22:23]
  v_pk_add_f32 v[24:25], v[24:25], v[26:27]
  v_pk_add_f32 v[20:21], v[20:21], v[24:25]
  v_add_f32 v20, v20, v21
  s_nop 1
  v_add_f32_dpp v20, v20, v20 quad_perm:[1,0,3,2] row_mask:0xf bank_mask:0xf
  s_nop 1
  v_add_f32_dpp v20, v20, v20 quad_perm:[2,3,0,1] row_mask:0xf bank_mask:0xf
  s_nop 1
  v_add_f32_dpp v20, v20, v20 row_half_mirror row_mask:0xf bank_mask:0xf
  v_mov_b32 v21, v20
  s_nop 1
  v_permlane16_swap_b32 v20, v21
  s_nop 0
  v_add_f32 v20, v20, v21
  v_mov_b32 v21, v20
  s_nop 1
  v_permlane32_swap_b32 v20, v21
  s_nop 0
  v_add_f32 v20, v20, v21
  v_mul_f32 v22, 0x3b000000, v20
  v_mul_f32 v23, 0x3b000000, v20
  v_pk_add_f32 v[20:21], v[32:33], v[22:23] neg_lo:[0,1] neg_hi:[0,1]
  v_pk_mul_f32 v[24:25], v[20:21], v[20:21]
  v_pk_add_f32 v[20:21], v[34:35], v[22:23] neg_lo:[0,1] neg_hi:[0,1]
  v_pk_fma_f32 v[24:25], v[20:21], v[20:21], v[24:25]
  v_pk_add_f32 v[20:21], v[36:37], v[22:23] neg_lo:[0,1] neg_hi:[0,1]
  v_pk_fma_f32 v[24:25], v[20:21], v[20:21], v[24:25]
  v_pk_add_f32 v[20:21], v[38:39], v[22:23] neg_lo:[0,1] neg_hi:[0,1]
  v_pk_fma_f32 v[24:25], v[20:21], v[20:21], v[24:25]
  v_pk_add_f32 v[20:21], v[40:41], v[22:23] neg_lo:[0,1] neg_hi:[0,1]
  v_pk_fma_f32 v[24:25], v[20:21], v[20:21], v[24:25]
  v_pk_add_f32 v[20:21], v[42:43], v[22:23] neg_lo:[0,1] neg_hi:[0,1]
  v_pk_fma_f32 v[24:25], v[20:21], v[20:21], v[24:25]
  v_pk_add_f32 v[20:21], v[44:45], v[22:23] neg_lo:[0,1] neg_hi:[0,1]
  v_pk_fma_f32 v[24:25], v[20:21], v[20:21], v[24:25]
  v_pk_add_f32 v[20:21], v[46:47], v[22:23] neg_lo:[0,1] neg_hi:[0,1]
  v_pk_fma_f32 v[24:25], v[20:21], v[20:21], v[24:25]
  v_add_f32 v24, v24, v25
  s_nop 1
  v_add_f32_dpp v24, v24, v24 quad_perm:[1,0,3,2] row_mask:0xf bank_mask:0xf
  s_nop 1
  v_add_f32_dpp v24, v24, v24 quad_perm:[2,3,0,1] row_mask:0xf bank_mask:0xf
  s_nop 1
  v_add_f32_dpp v24, v24, v24 row_half_mirror row_mask:0xf bank_mask:0xf
  v_mov_b32 v25, v24
  s_nop 1
  v_permlane16_swap_b32 v24, v25
  s_nop 0
  v_add_f32 v24, v24, v25
  v_mov_b32 v25, v24
  s_nop 1
  v_permlane32_swap_b32 v24, v25
  s_nop 0
  v_add_f32 v24, v24, v25
  v_mul_f32 v24, 0x3b000000, v24
  v_cvt_pk_bf16_f32 v24, v22, v24
  v_lshlrev_b32 v22, 16, v24
  v_and_b32 v24, 0xffff0000, v24
  v_add_f32 v24, 0x3727c5ac, v24
  v_mov_b32 v23, v22
  v_cvt_pk_bf16_f32 v24, v24, v24
  v_lshlrev_b32 v24, 16, v24
  v_sqrt_f32 v24, v24
  v_pk_add_f32 v[32:33], v[32:33], v[22:23] neg_lo:[0,1] neg_hi:[0,1]
  v_pk_add_f32 v[34:35], v[34:35], v[22:23] neg_lo:[0,1] neg_hi:[0,1]
  v_pk_add_f32 v[36:37], v[36:37], v[22:23] neg_lo:[0,1] neg_hi:[0,1]
  v_pk_add_f32 v[38:39], v[38:39], v[22:23] neg_lo:[0,1] neg_hi:[0,1]
  v_pk_add_f32 v[40:41], v[40:41], v[22:23] neg_lo:[0,1] neg_hi:[0,1]
  v_pk_add_f32 v[42:43], v[42:43], v[22:23] neg_lo:[0,1] neg_hi:[0,1]
  v_pk_add_f32 v[44:45], v[44:45], v[22:23] neg_lo:[0,1] neg_hi:[0,1]
  v_pk_add_f32 v[46:47], v[46:47], v[22:23] neg_lo:[0,1] neg_hi:[0,1]
  v_cvt_pk_bf16_f32 v24, v24, v24
  v_lshlrev_b32 v24, 16, v24
  v_rcp_f32 v20, v24
  v_mov_b32 v25, v24
  v_cvt_pk_bf16_f32 v33, v32, v33
  v_lshlrev_b32 v32, 16, v33
  v_and_b32 v33, 0xffff0000, v33
  v_cvt_pk_bf16_f32 v35, v34, v35
  v_lshlrev_b32 v34, 16, v35
  v_and_b32 v35, 0xffff0000, v35
  v_cvt_pk_bf16_f32 v37, v36, v37
  v_lshlrev_b32 v36, 16, v37
  v_and_b32 v37, 0xffff0000, v37
  v_cvt_pk_bf16_f32 v39, v38, v39
  v_lshlrev_b32 v38, 16, v39
  v_and_b32 v39, 0xffff0000, v39
  v_cvt_pk_bf16_f32 v41, v40, v41
  v_lshlrev_b32 v40, 16, v41
  v_and_b32 v41, 0xffff0000, v41
  v_cvt_pk_bf16_f32 v43, v42, v43
  v_lshlrev_b32 v42, 16, v43
  v_and_b32 v43, 0xffff0000, v43
  v_cvt_pk_bf16_f32 v45, v44, v45
  v_lshlrev_b32 v44, 16, v45
  v_and_b32 v45, 0xffff0000, v45
  v_cvt_pk_bf16_f32 v47, v46, v47
  v_lshlrev_b32 v46, 16, v47
  v_and_b32 v47, 0xffff0000, v47
  v_mov_b32 v21, v20
  v_pk_mul_f32 v[26:27], v[32:33], v[20:21]
  v_pk_fma_f32 v[32:33], v[26:27], v[24:25], v[32:33] neg_lo:[1,0,0] neg_hi:[1,0,0]
  v_pk_fma_f32 v[32:33], v[32:33], v[20:21], v[26:27]
  v_cvt_pk_bf16_f32 v8, v32, v33
  v_min_u32 v8, -2, v8
  v_pk_mul_f32 v[26:27], v[34:35], v[20:21]
  v_pk_fma_f32 v[34:35], v[26:27], v[24:25], v[34:35] neg_lo:[1,0,0] neg_hi:[1,0,0]
  v_pk_fma_f32 v[34:35], v[34:35], v[20:21], v[26:27]
  v_cvt_pk_bf16_f32 v9, v34, v35
  v_min_u32 v9, -2, v9
  v_pk_mul_f32 v[26:27], v[36:37], v[20:21]
  v_pk_fma_f32 v[36:37], v[26:27], v[24:25], v[36:37] neg_lo:[1,0,0] neg_hi:[1,0,0]
  v_pk_fma_f32 v[36:37], v[36:37], v[20:21], v[26:27]
  v_cvt_pk_bf16_f32 v10, v36, v37
  v_min_u32 v10, -2, v10
  v_pk_mul_f32 v[26:27], v[38:39], v[20:21]
  v_pk_fma_f32 v[38:39], v[26:27], v[24:25], v[38:39] neg_lo:[1,0,0] neg_hi:[1,0,0]
  v_pk_fma_f32 v[38:39], v[38:39], v[20:21], v[26:27]
  v_cvt_pk_bf16_f32 v11, v38, v39
  v_min_u32 v11, -2, v11
  v_pk_mul_f32 v[26:27], v[40:41], v[20:21]
  v_pk_fma_f32 v[40:41], v[26:27], v[24:25], v[40:41] neg_lo:[1,0,0] neg_hi:[1,0,0]
  v_pk_fma_f32 v[40:41], v[40:41], v[20:21], v[26:27]
  v_cvt_pk_bf16_f32 v12, v40, v41
  v_min_u32 v12, -2, v12
  v_pk_mul_f32 v[26:27], v[42:43], v[20:21]
  v_pk_fma_f32 v[42:43], v[26:27], v[24:25], v[42:43] neg_lo:[1,0,0] neg_hi:[1,0,0]
  v_pk_fma_f32 v[42:43], v[42:43], v[20:21], v[26:27]
  v_cvt_pk_bf16_f32 v13, v42, v43
  v_min_u32 v13, -2, v13
  v_pk_mul_f32 v[26:27], v[44:45], v[20:21]
  v_pk_fma_f32 v[44:45], v[26:27], v[24:25], v[44:45] neg_lo:[1,0,0] neg_hi:[1,0,0]
  v_pk_fma_f32 v[44:45], v[44:45], v[20:21], v[26:27]
  v_cvt_pk_bf16_f32 v14, v44, v45
  v_min_u32 v14, -2, v14
  v_pk_mul_f32 v[26:27], v[46:47], v[20:21]
  v_pk_fma_f32 v[46:47], v[26:27], v[24:25], v[46:47] neg_lo:[1,0,0] neg_hi:[1,0,0]
  v_pk_fma_f32 v[46:47], v[46:47], v[20:21], v[26:27]
  v_cvt_pk_bf16_f32 v15, v46, v47
  v_min_u32 v15, -2, v15
  ds_write_b128 v4, v[8:11]
  ds_write_b128 v4, v[12:15] offset:512
  v_add_u32 v4, 2048, v4
  s_cmp_eq_u32 s52, 1
  s_mov_b32 s52, 2
  s_cbranch_scc1 L_ln
  s_cmp_lt_u32 s31, 24
  s_cbranch_scc1 L_nox
  buffer_load_ushort v50, v1, s[32:35], s45 offen
  buffer_load_ushort v51, v1, s[36:39], s46 offen
L_nox:
  v_lshrrev_b32 v30, 1, v6
  v_lshlrev_b32 v30, 11, v30
  v_and_b32 v29, 31, v0
  v_lshl_add_u32 v30, v29, 4, v30
  s_cmp_ge_u32 s31, 28
  s_cbranch_scc1 L_nom2
  s_mul_i32 s48, s30, 28
  s_add_u32 s48, s48, s31
  s_lshr_b32 s49, s48, 2
  s_and_b32 s48, s48, 3
  v_lshlrev_b32 v4, 2, v2
  v_add_u32 v4, 132544, v4
  s_lshl_b32 s57, s49, 12
  s_lshl_b32 s51, s48, 9
  s_add_u32 s57, s57, s51
  s_add_u32 s57, s57, 1572864
  v_and_b32 v31, 0xff, v5
L_kw2:
  ds_read_b32 v28, v4
  s_waitcnt lgkmcnt(0)
  v_cmp_eq_u32 vcc, -1, v28
  s_cmp_eq_u64 vcc, 0
  s_cbranch_scc1 L_kw2_ok
  s_sleep 4
  s_sub_u32 s62, s62, 1
  s_cbranch_scc0 L_kw2
  s_mov_b32 s62, 0
L_kw2_ok:
  s_mov_b64 s[36:37], s[18:19]
  s_mov_b32 s38, 3584
  s_mov_b32 s39, 0x20000
  v_lshlrev_b32 v4, 3, v6
  s_lshl_b32 s47, s49, 6
  buffer_load_dwordx2 v[24:25], v4, s[36:39], s47 offen
  buffer_load_dwordx2 v[26:27], v4, s[36:39], s47 offen offset:32
  v_and_b32 v3, 3, v0
  v_lshlrev_b32 v3, 9, v3
  v_lshl_add_u32 v3, v6, 4, v3
  v_bfe_u32 v4, v0, 3, 1
  v_lshl_add_u32 v3, v4, 8, v3
  s_lshr_b32 s47, s49, 1
  s_lshl_b32 s47, s47, 11
  s_and_b32 s50, s49, 1
  s_lshl_b32 s50, s50, 7
  s_add_u32 s47, s47, s50
  s_add_u32 s47, s47, 262144
  buffer_load_dwordx4 v[8:11], v3, s[40:43], s47 offen sc1
  buffer_load_dwordx4 v[12:15], v3, s[40:43], s47 offen offset:64 sc1
  s_mov_b64 s[36:37], s[20:21]
  s_mov_b32 s38, 1835008
  s_mov_b32 s39, 0x20000
  s_lshl_b32 s46, s49, 15
  s_lshl_b32 s50, s48, 8
  s_add_u32 s46, s46, s50
  s_add_u32 s50, s46, 16384
  v_lshlrev_b32 v4, 12, v6
  v_lshl_add_u32 v4, v7, 4, v4
  buffer_load_dwordx4 v[64:67], v4, s[36:39], s46 offen offset:0 nt
  buffer_load_dwordx4 v[68:71], v4, s[36:39], s46 offen offset:1024 nt
  buffer_load_dwordx4 v[72:75], v4, s[36:39], s46 offen offset:2048 nt
  buffer_load_dwordx4 v[76:79], v4, s[36:39], s46 offen offset:3072 nt
  buffer_load_dwordx4 v[80:83], v4, s[36:39], s50 offen offset:0 nt
  buffer_load_dwordx4 v[84:87], v4, s[36:39], s50 offen offset:1024 nt
  buffer_load_dwordx4 v[88:91], v4, s[36:39], s50 offen offset:2048 nt
  buffer_load_dwordx4 v[92:95], v4, s[36:39], s50 offen offset:3072 nt
  s_setprio 1
  s_waitcnt vmcnt(8)
  s_branch L_uc
L_ur:
  buffer_load_dwordx4 v[8:11], v3, s[40:43], s47 offen sc1
  buffer_load_dwordx4 v[12:15], v3, s[40:43], s47 offen offset:64 sc1
  s_waitcnt vmcnt(0)
L_uc:
  v_xor_b32 v8, v31, v8
  v_xor_b32 v9, v31, v9
  v_xor_b32 v10, v31, v10
  v_xor_b32 v11, v31, v11
  v_xor_b32 v12, v31, v12
  v_xor_b32 v13, v31, v13
  v_xor_b32 v14, v31, v14
  v_xor_b32 v15, v31, v15
  v_or3_b32 v28, v8, v9, v10
  v_or3_b32 v28, v28, v11, v12
  v_or3_b32 v28, v28, v13, v14
  v_or_b32 v28, v28, v15
  v_and_b32 v28, 0xff, v28
  v_cmp_ne_u32 vcc, 0, v28
  s_wqm_b64 exec, vcc
  s_cbranch_scc0 L_u_ok
  s_sleep 4
  s_sub_u32 s62, s62, 1
  s_cbranch_scc0 L_ur
  s_mov_b32 s62, 0
L_u_ok:
  s_mov_b64 exec, -1
  v_add_f32_dpp v8, v8, v8 quad_perm:[1,0,3,2] row_mask:0xf bank_mask:0xf
  v_add_f32_dpp v9, v9, v9 quad_perm:[1,0,3,2] row_mask:0xf bank_mask:0xf
  v_add_f32_dpp v10, v10, v10 quad_perm:[1,0,3,2] row_mask:0xf bank_mask:0xf
  v_add_f32_dpp v11, v11, v11 quad_perm:[1,0,3,2] row_mask:0xf bank_mask:0xf
  v_add_f32_dpp v12, v12, v12 quad_perm:[1,0,3,2] row_mask:0xf bank_mask:0xf
  v_add_f32_dpp v13, v13, v13 quad_perm:[1,0,3,2] row_mask:0xf bank_mask:0xf
  v_add_f32_dpp v14, v14, v14 quad_perm:[1,0,3,2] row_mask:0xf bank_mask:0xf
  v_add_f32_dpp v15, v15, v15 quad_perm:[1,0,3,2] row_mask:0xf bank_mask:0xf
  v_add_f32_dpp v8, v8, v8 quad_perm:[2,3,0,1] row_mask:0xf bank_mask:0xf
  v_add_f32_dpp v9, v9, v9 quad_perm:[2,3,0,1] row_mask:0xf bank_mask:0xf
  v_add_f32_dpp v10, v10, v10 quad_perm:[2,3,0,1] row_mask:0xf bank_mask:0xf
  v_add_f32_dpp v11, v11, v11 quad_perm:[2,3,0,1] row_mask:0xf bank_mask:0xf
  v_add_f32_dpp v12, v12, v12 quad_perm:[2,3,0,1] row_mask:0xf bank_mask:0xf
  v_add_f32_dpp v13, v13, v13 quad_perm:[2,3,0,1] row_mask:0xf bank_mask:0xf
  v_add_f32_dpp v14, v14, v14 quad_perm:[2,3,0,1] row_mask:0xf bank_mask:0xf
  v_add_f32_dpp v15, v15, v15 quad_perm:[2,3,0,1] row_mask:0xf bank_mask:0xf
  v_cvt_pk_bf16_f32 v9, v8, v9
  v_lshlrev_b32 v8, 16, v9
  v_and_b32 v9, 0xffff0000, v9
  v_lshlrev_b32 v28, 16, v24
  v_and_b32 v29, 0xffff0000, v24
  v_add_f32 v8, v8, v28
  v_add_f32 v9, v9, v29
  v_cvt_pk_bf16_f32 v9, v8, v9
  v_lshlrev_b32 v8, 16, v9
  v_and_b32 v9, 0xffff0000, v9
  v_cvt_pk_bf16_f32 v11, v10, v11
  v_lshlrev_b32 v10, 16, v11
  v_and_b32 v11, 0xffff0000, v11
  v_lshlrev_b32 v28, 16, v25
  v_and_b32 v29, 0xffff0000, v25
  v_add_f32 v10, v10, v28
  v_add_f32 v11, v11, v29
  v_cvt_pk_bf16_f32 v11, v10, v11
  v_lshlrev_b32 v10, 16, v11
  v_and_b32 v11, 0xffff0000, v11
  v_cvt_pk_bf16_f32 v13, v12, v13
  v_lshlrev_b32 v12, 16, v13
  v_and_b32 v13, 0xffff0000, v13
  v_lshlrev_b32 v28, 16, v26
  v_and_b32 v29, 0xffff0000, v26
  v_add_f32 v12, v12, v28
  v_add_f32 v13, v13, v29
  v_cvt_pk_bf16_f32 v13, v12, v13
  v_lshlrev_b32 v12, 16, v13
  v_and_b32 v13, 0xffff0000, v13
  v_cvt_pk_bf16_f32 v15, v14, v15
  v_lshlrev_b32 v14, 16, v15
  v_and_b32 v15, 0xffff0000, v15
  v_lshlrev_b32 v28, 16, v27
  v_and_b32 v29, 0xffff0000, v27
  v_add_f32 v14, v14, v28
  v_add_f32 v15, v15, v29
  v_cvt_pk_bf16_f32 v15, v14, v15
  v_lshlrev_b32 v14, 16, v15
  v_and_b32 v15, 0xffff0000, v15
  s_mov_b32 s50, 0xc0135761
  s_mov_b32 s51, 0x3d372713
  v_mul_f32 v32, v8, v8
  v_mul_f32 v32, s51, v32
  v_fma_f32 v32, v32, v8, v8
  v_mul_f32 v32, s50, v32
  v_mul_f32 v33, v9, v9
  v_mul_f32 v33, s51, v33
  v_fma_f32 v33, v33, v9, v9
  v_mul_f32 v33, s50, v33
  v_mul_f32 v34, v10, v10
  v_mul_f32 v34, s51, v34
  v_fma_f32 v34, v34, v10, v10
  v_mul_f32 v34, s50, v34
  v_mul_f32 v35, v11, v11
  v_mul_f32 v35, s51, v35
  v_fma_f32 v35, v35, v11, v11
  v_mul_f32 v35, s50, v35
  v_mul_f32 v36, v12, v12
  v_mul_f32 v36, s51, v36
  v_fma_f32 v36, v36, v12, v12
  v_mul_f32 v36, s50, v36
  v_mul_f32 v37, v13, v13
  v_mul_f32 v37, s51, v37
  v_fma_f32 v37, v37, v13, v13
  v_mul_f32 v37, s50, v37
  v_mul_f32 v38, v14, v14
  v_mul_f32 v38, s51, v38
  v_fma_f32 v38, v38, v14, v14
  v_mul_f32 v38, s50, v38
  v_mul_f32 v39, v15, v15
  v_mul_f32 v39, s51, v39
  v_fma_f32 v39, v39, v15, v15
  v_mul_f32 v39, s50, v39
  v_exp_f32 v32, v32
  v_exp_f32 v33, v33
  v_exp_f32 v34, v34
  v_exp_f32 v35, v35
  v_exp_f32 v36, v36
  v_exp_f32 v37, v37
  v_exp_f32 v38, v38
  v_exp_f32 v39, v39
  v_add_f32 v32, 1.0, v32
  v_add_f32 v33, 1.0, v33
  v_add_f32 v34, 1.0, v34
  v_add_f32 v35, 1.0, v35
  v_add_f32 v36, 1.0, v36
  v_add_f32 v37, 1.0, v37
  v_add_f32 v38, 1.0, v38
  v_add_f32 v39, 1.0, v39
  v_rcp_f32 v32, v32
  v_rcp_f32 v33, v33
  v_rcp_f32 v34, v34
  v_rcp_f32 v35, v35
  v_rcp_f32 v36, v36
  v_rcp_f32 v37, v37
  v_rcp_f32 v38, v38
  v_rcp_f32 v39, v39
  v_mul_f32 v8, v8, v32
  v_mul_f32 v9, v9, v33
  v_mul_f32 v10, v10, v34
  v_mul_f32 v11, v11, v35
  v_mul_f32 v12, v12, v36
  v_mul_f32 v13, v13, v37
  v_mul_f32 v14, v14, v38
  v_mul_f32 v15, v15, v39
  v_cvt_pk_bf16_f32 v32, v8, v9
  v_cvt_pk_bf16_f32 v33, v10, v11
  v_cvt_pk_bf16_f32 v34, v12, v13
  v_cvt_pk_bf16_f32 v35, v14, v15
  s_mov_b32 s64, 0xffff0000
  s_mov_b32 s65, 0xffff0000
  s_waitcnt vmcnt(0)
  v_perm_b32 v128, v68, v64, s60
  v_perm_b32 v132, v68, v64, s61
  v_perm_b32 v136, v69, v65, s60
  v_perm_b32 v140, v69, v65, s61
  v_perm_b32 v144, v70, v66, s60
  v_perm_b32 v148, v70, v66, s61
  v_perm_b32 v152, v71, v67, s60
  v_perm_b32 v156, v71, v67, s61
  v_perm_b32 v129, v76, v72, s60
  v_perm_b32 v133, v76, v72, s61
  v_perm_b32 v137, v77, v73, s60
  v_perm_b32 v141, v77, v73, s61
  v_perm_b32 v145, v78, v74, s60
  v_perm_b32 v149, v78, v74, s61
  v_perm_b32 v153, v79, v75, s60
  v_perm_b32 v157, v79, v75, s61
  v_perm_b32 v130, v84, v80, s60
  v_perm_b32 v134, v84, v80, s61
  v_perm_b32 v138, v85, v81, s60
  v_perm_b32 v142, v85, v81, s61
  v_perm_b32 v146, v86, v82, s60
  v_perm_b32 v150, v86, v82, s61
  v_perm_b32 v154, v87, v83, s60
  v_perm_b32 v158, v87, v83, s61
  v_perm_b32 v131, v92, v88, s60
  v_perm_b32 v135, v92, v88, s61
  v_perm_b32 v139, v93, v89, s60
  v_perm_b32 v143, v93, v89, s61
  v_perm_b32 v147, v94, v90, s60
  v_perm_b32 v151, v94, v90, s61
  v_perm_b32 v155, v95, v91, s60
  v_perm_b32 v159, v95, v91, s61
  s_nop 1
  v_mfma_f32_16x16x32_bf16 v[64:67], v[32:35], v[128:131], 0
  v_mfma_f32_16x16x32_bf16 v[80:83], v[32:35], v[144:147], 0
  v_mfma_f32_16x16x32_bf16 v[68:71], v[32:35], v[132:135], 0
  v_mfma_f32_16x16x32_bf16 v[84:87], v[32:35], v[148:151], 0
  v_mfma_f32_16x16x32_bf16 v[72:75], v[32:35], v[136:139], 0
  v_mfma_f32_16x16x32_bf16 v[88:91], v[32:35], v[152:155], 0
  v_mfma_f32_16x16x32_bf16 v[76:79], v[32:35], v[140:143], 0
  v_mfma_f32_16x16x32_bf16 v[92:95], v[32:35], v[156:159], 0
  s_nop 1
  v_cndmask_b32 v40, v64, v80, s[64:65]
  v_and_or_b32 v40, v40, s63, v5
  v_cndmask_b32 v41, v68, v84, s[64:65]
  v_and_or_b32 v41, v41, s63, v5
  v_cndmask_b32 v42, v72, v88, s[64:65]
  v_and_or_b32 v42, v42, s63, v5
  v_cndmask_b32 v43, v76, v92, s[64:65]
  v_and_or_b32 v43, v43, s63, v5
  s_setprio 3
L_nom2:
  s_lshl_b32 s49, s30, 11
  s_bfe_u32 s47, s31, 0x10003
  s_lshl_b32 s47, s47, 8
  s_add_u32 s49, s49, s47
  s_lshr_b32 s47, s31, 4
  s_lshl_b32 s47, s47, 7
  s_add_u32 s49, s49, s47
  s_and_b32 s47, s31, 7
  s_lshl_b32 s47, s47, 4
  s_add_u32 s49, s49, s47
  s_add_u32 s49, s49, 327680
  v_lshlrev_b32 v20, 9, v6
  v_lshl_add_u32 v2, v6, 3, v2
  v_lshlrev_b32 v3, 3, v2
  v_add_u32 v3, 132096, v3
  v_lshlrev_b32 v4, 2, v2
  v_add_u32 v4, 132352, v4
  s_mov_b32 s48, 1069066811
  v_mov_b32 v23, 137728
  v_mov_b32 v18, v5
  v_mov_b32 v19, v5
  v_lshrrev_b32 v2, 2, v0
  v_lshlrev_b32 v2, 12, v2
  v_and_b32 v21, 3, v0
  v_lshl_add_u32 v2, v21, 4, v2
  v_and_b32 v21, 7, v0
  s_mov_b32 s64, 0x10001
  s_mov_b32 s65, 0x10001
  s_lshl_b32 s47, s44, 6
L_mlw:
  ds_read_b64 v[8:9], v3
  ds_read_b32 v22, v23
  s_waitcnt lgkmcnt(0)
  v_cmp_eq_u32 vcc, -1, v9
  s_cmp_eq_u64 vcc, 0
  s_cbranch_scc1 L_mlw_ok
  s_sleep 2
  s_sub_u32 s62, s62, 1
  s_cbranch_scc0 L_mlw
  s_mov_b32 s62, 0
L_mlw_ok:
  v_mov_b32 v10, v8
  v_readfirstlane_b32 s54, v22
  s_nop 1
  v_max_f32_dpp v10, v10, v10 quad_perm:[1,0,3,2] row_mask:0xf bank_mask:0xf
  s_nop 1
  v_max_f32_dpp v10, v10, v10 quad_perm:[2,3,0,1] row_mask:0xf bank_mask:0xf
  s_nop 1
  v_max_f32_dpp v10, v10, v10 row_half_mirror row_mask:0xf bank_mask:0xf
  v_mul_f32 v8, s48, v8
  v_fma_f32 v12, v10, s48, -v8
  v_exp_f32 v12, -v12
  s_nop 0
  v_mul_f32 v11, v9, v12
  v_min_u32 v12, -2, v12
  s_nop 1
  v_add_f32_dpp v11, v11, v11 quad_perm:[1,0,3,2] row_mask:0xf bank_mask:0xf
  s_nop 1
  v_add_f32_dpp v11, v11, v11 quad_perm:[2,3,0,1] row_mask:0xf bank_mask:0xf
  s_nop 1
  v_add_f32_dpp v11, v11, v11 row_half_mirror row_mask:0xf bank_mask:0xf
  v_and_or_b32 v16, v10, s63, v5
  v_and_or_b32 v17, v11, s63, v5
  s_mov_b64 exec, s[64:65]
  s_cmp_eq_u32 s54, 0
  s_cbranch_scc1 L_mslow
  buffer_store_dwordx4 v[16:19], v20, s[40:43], s49 offen
  s_branch L_mdone
L_mslow:
  buffer_store_dwordx4 v[16:19], v20, s[40:43], s49 offen sc1
L_mdone:
  s_mov_b64 exec, -1
  ds_write_b32 v4, v12
  s_cmp_ge_u32 s31, 28
  s_cbranch_scc1 L_nomw
  v_mov_b32 v4, 132584
  s_setprio 0
L_mw:
  ds_read_b32 v28, v4
  s_waitcnt lgkmcnt(0)
  v_cmp_eq_u32 vcc, -1, v28
  s_cmp_eq_u64 vcc, 0
  s_cbranch_scc1 L_mw_ok
  s_sleep 1
  s_sub_u32 s62, s62, 1
  s_cbranch_scc0 L_mw
  s_mov_b32 s62, 0
L_mw_ok:
  buffer_store_dwordx4 v[40:43], v30, s[40:43], s57 offen sc1
L_nomw:
  s_cmp_lt_u32 s31, 24
  s_cbranch_scc1 L_end
  s_mov_b64 s[36:37], s[24:25]
  s_mov_b32 s38, 2048
  s_mov_b32 s39, 0x20000
  v_lshlrev_b32 v3, 4, v21
  v_lshl_add_u32 v3, v6, 2, v3
  v_add_u32 v3, 136704, v3
  s_sub_u32 s47, s2, 224
  v_or_b32 v26, s47, v0
  v_min_u32 v26, 1, v26
  v_lshlrev_b32 v26, 29, v26
  s_mov_b32 s48, 0xbfb8aa3b
  s_mov_b32 s64, 0xf000f
  s_mov_b32 s65, 0xf000f
  s_waitcnt vmcnt(1)
  v_lshlrev_b32 v50, 16, v50
  v_lshlrev_b32 v51, 16, v51
  s_setprio 3
  s_barrier
  ds_read2_b32 v[8:9], v3 offset0:0 offset1:32
  ds_read2_b32 v[10:11], v3 offset0:64 offset1:96
  ds_read2_b32 v[12:13], v3 offset0:128 offset1:160
  ds_read2_b32 v[14:15], v3 offset0:192 offset1:224
  buffer_store_dword v59, v26, s[40:43], 0 offen offset:0 sc1
  s_waitcnt lgkmcnt(0)
  v_pk_add_f32 v[8:9], v[8:9], v[10:11]
  v_pk_add_f32 v[12:13], v[12:13], v[14:15]
  v_pk_add_f32 v[8:9], v[8:9], v[12:13]
  v_add_f32 v24, v8, v9
  v_cvt_pk_bf16_f32 v24, v24, v24
  v_lshlrev_b32 v24, 16, v24
  v_add_f32 v8, v24, v51
  v_cvt_pk_bf16_f32 v8, v8, v8
  v_lshlrev_b32 v8, 16, v8
  v_mul_f32 v21, s48, v8
  v_exp_f32 v21, v21
  s_nop 0
  v_add_f32 v21, 1.0, v21
  v_rcp_f32 v21, v21
  s_nop 0
  v_mul_f32 v8, v8, v21
  v_cvt_pk_bf16_f32 v8, v8, v8
  v_lshlrev_b32 v8, 16, v8
  s_nop 1
  v_mul_f32_dpp v24, v8, v24 row_ror:4 row_mask:0xf bank_mask:0xf
  s_mov_b64 exec, s[64:65]
  v_cvt_pk_bf16_f32 v24, v24, v24
  v_lshlrev_b32 v24, 16, v24
  v_add_f32 v24, v24, v50
  v_cvt_pk_bf16_f32 v24, v24, v24
  buffer_store_short v24, v1, s[36:39], s45 offen
L_end:
  s_endpgm

.section .rodata,"a"
.p2align 6
.amdhsa_kernel recurrent_scan__gqa_block_cached__mixer_channel_mlp__decode_kernel
  .amdhsa_next_free_vgpr 168
  .amdhsa_next_free_sgpr 102
  .amdhsa_accum_offset 168
  .amdhsa_group_segment_fixed_size 0
  .amdhsa_kernarg_size 104
  .amdhsa_user_sgpr_count 2
  .amdhsa_user_sgpr_kernarg_segment_ptr 1
  .amdhsa_system_sgpr_workgroup_id_x 1
  .amdhsa_float_denorm_mode_32 3
  .amdhsa_float_denorm_mode_16_64 3
.end_amdhsa_kernel
```
